```python
import torch

def _softmax(x, axis=-1):
    return torch.softmax(x, dim=axis)
def _gelu(x):
    return torch.nn.functional.gelu(x, approximate="tanh")
def _silu(x):
    return torch.nn.functional.silu(x)
def _sigmoid(x):
    return torch.sigmoid(x)
def _layernorm(x, axis=-1, eps=1e-5):
    m = x.mean(dim=axis, keepdim=True)
    v = x.var(dim=axis, keepdim=True, unbiased=False)
    return (x - m) / torch.sqrt(v + eps)
def _scatter_add(tgt, idx, src, axis=0):
    return tgt.clone().index_add_(axis, idx, src)
def _segment_sum(src, seg, n):
    out = torch.zeros((n,) + src.shape[1:], dtype=src.dtype)
    return out.index_add_(0, seg, src)
def _pad(x, pw):
    flat = tuple(v for pair in reversed(pw) for v in pair)
    return torch.nn.functional.pad(x, flat)

kernel_name = 'standalone__mha_block_cached__decode'

def setup_inputs():

    _w = (lambda a: (lambda t: t.to(torch.bfloat16) if t.is_floating_point() else t)(torch.as_tensor(a)))
    B, Sq, D = 4, 1, 512
    H, Sk, Dh = 32, 4096, 128
    return {
        "x": _w((lambda *s: torch.randn(*s, dtype=torch.bfloat16) * 0.8)(B, Sq, D)),
        "k_cache": _w((lambda *s: torch.randn(*s, dtype=torch.bfloat16) * 0.8)(B, H, Sk, Dh)),
        "v_cache": _w((lambda *s: torch.randn(*s, dtype=torch.bfloat16) * 0.05)(B, H, Sk, Dh)),
        "wq": _w((lambda *s: torch.randn(*s, dtype=torch.bfloat16) * 0.8)(D, H * Dh) * (D ** -0.5)),
        "wo": _w((lambda *s: torch.randn(*s, dtype=torch.bfloat16) * 0.05)(H * Dh, D) * ((H * Dh) ** -0.5)),
    }

def reference(x, k_cache, v_cache, wq, wo):
    B, Sq, D = x.shape
    H, Dh = 32, 128
    q = (lambda x, *d: x.permute(*d))((x @ wq).reshape(B, Sq, H, Dh), 0, 2, 1, 3)
    scores = torch.einsum("bhqd,bhkd->bhqk", q, k_cache) * (Dh ** -0.5)
    p = _softmax(scores, axis=-1)
    o = torch.einsum("bhqk,bhkd->bhqd", p, v_cache)
    return (lambda x, *d: x.permute(*d))(o, 0, 2, 1, 3).reshape(B, Sq, H * Dh) @ wo
```

```asm
; @launch grid=(256,1,1) block=(320,1,1) lds=36160
.amdgcn_target "amdgcn-amd-amdhsa--gfx950"
.text
.globl standalone__mha_block_cached__decode_kernel
.p2align 8
.type standalone__mha_block_cached__decode_kernel,@function
standalone__mha_block_cached__decode_kernel:
  s_cmp_ge_u32 s2, 256
  s_cbranch_scc1 L_end_standalone__mha_block_cached__decode_kernel
  s_load_dwordx8 s[4:11], s[0:1], 0
  s_load_dwordx8 s[12:19], s[0:1], 32
  v_lshrrev_b32 v58, 6, v0
  s_mov_b32 s52, 0
  s_bfe_u32 s63, s2, 65536
  s_or_b32 s52, s52, s63
  s_bfe_u32 s63, s2, 131073
  s_lshl_b32 s63, s63, 2
  s_or_b32 s52, s52, s63
  s_bfe_u32 s63, s2, 65539
  s_lshl_b32 s63, s63, 1
  s_or_b32 s52, s52, s63
  s_bfe_u32 s63, s2, 65540
  s_lshl_b32 s63, s63, 4
  s_or_b32 s52, s52, s63
  s_lshr_b32 s82, s2, 5
  s_lshr_b32 s53, s82, 1
  s_and_b32 s54, s82, 1
  v_readfirstlane_b32 s55, v58
  v_and_b32 v59, 63, v0
  v_lshrrev_b32 v60, 4, v59
  v_and_b32 v61, 15, v0
  s_lshl_b32 s86, s52, 1
  s_add_u32 s86, s86, s54
  s_lshl_b32 s87, s53, 6
  s_add_u32 s87, s87, s86
  s_cmp_ge_u32 s55, 4
  s_cbranch_scc1 L_helper_standalone__mha_block_cached__decode_kernel
  v_lshlrev_b32 v1, 4, v0
  s_lshl_b32 s63, s53, 5
  s_add_u32 s63, s63, s52
  s_lshl_b32 s63, s63, 20
  s_lshl_b32 s64, s54, 19
  s_add_u32 s63, s63, s64
  s_lshl_b32 s58, s52, 17
  s_mov_b32 s56, 0
  s_mov_b32 s26, 524288
  s_mov_b32 s27, 0x20000
  v_mov_b32 v41, 0
  s_waitcnt lgkmcnt(0)
  s_add_u32 s24, s6, s63
  s_addc_u32 s25, s7, 0
  buffer_load_dwordx4 v[64:67], v1, s[24:27], s56 offen nt
  s_add_u32 s56, s56, 4096
  buffer_load_dwordx4 v[68:71], v1, s[24:27], s56 offen nt
  s_add_u32 s56, s56, 4096
  buffer_load_dwordx4 v[72:75], v1, s[24:27], s56 offen nt
  s_add_u32 s56, s56, 4096
  buffer_load_dwordx4 v[76:79], v1, s[24:27], s56 offen nt
  s_add_u32 s56, s56, 4096
  buffer_load_dwordx4 v[80:83], v1, s[24:27], s56 offen nt
  s_add_u32 s56, s56, 4096
  buffer_load_dwordx4 v[84:87], v1, s[24:27], s56 offen nt
  s_add_u32 s56, s56, 4096
  buffer_load_dwordx4 v[88:91], v1, s[24:27], s56 offen nt
  s_add_u32 s56, s56, 4096
  buffer_load_dwordx4 v[92:95], v1, s[24:27], s56 offen nt
  s_add_u32 s56, s56, 4096
  s_add_u32 s28, s8, s63
  s_addc_u32 s29, s9, 0
  s_mov_b32 s30, 524288
  s_mov_b32 s31, 0x20000
  s_mov_b32 s36, s12
  s_mov_b32 s37, s13
  s_mov_b32 s38, 4194304
  s_mov_b32 s39, 0x20000
  s_mov_b32 s48, s18
  s_mov_b32 s49, s19
  s_mov_b32 s50, 536870912
  s_mov_b32 s51, 0x20000
  s_mov_b32 s59, 0x05040100
  s_mov_b32 s60, 0x07060302
  s_mov_b32 s61, 0x3e0293ee
  v_mov_b32 v8, 0
  v_mov_b32 v9, 0
  v_mov_b32 v10, 0
  v_mov_b32 v11, 0
  v_mov_b32 v12, 0
  v_mov_b32 v13, 0
  v_mov_b32 v14, 0
  v_mov_b32 v15, 0
  v_mov_b32 v48, 0xff7fffff
  v_mov_b32 v49, 0
  v_lshlrev_b32 v3, 10, v60
  v_lshl_add_u32 v3, v58, 8, v3
  v_lshl_add_u32 v3, v61, 4, v3
  v_lshlrev_b32 v5, 9, v58
  v_lshl_add_u32 v5, v61, 5, v5
  v_lshl_add_u32 v5, v60, 3, v5
  v_lshlrev_b32 v6, 4, v61
  v_lshlrev_b32 v7, 13, v58
  v_lshl_add_u32 v7, v59, 4, v7
  v_lshlrev_b32 v43, 5, v61
  v_lshl_add_u32 v43, v60, 2, v43
  v_add_u32 v43, 34112, v43
  v_add_u32 v37, 1024, v43
  s_barrier
  s_waitcnt vmcnt(7)
  buffer_load_dwordx4 v[96:99], v1, s[24:27], s56 offen nt
  s_add_u32 s56, s56, 4096
  s_waitcnt vmcnt(7)
  buffer_load_dwordx4 v[100:103], v1, s[24:27], s56 offen nt
  s_add_u32 s56, s56, 4096
  s_waitcnt vmcnt(7)
  buffer_load_dwordx4 v[104:107], v1, s[24:27], s56 offen nt
  s_add_u32 s56, s56, 4096
  s_waitcnt vmcnt(7)
  buffer_load_dwordx4 v[108:111], v1, s[24:27], s56 offen nt
  s_add_u32 s56, s56, 4096
  s_waitcnt vmcnt(7)
  buffer_load_dwordx4 v[112:115], v1, s[24:27], s56 offen nt
  s_add_u32 s56, s56, 4096
  s_waitcnt vmcnt(7)
  buffer_load_dwordx4 v[116:119], v1, s[24:27], s56 offen nt
  s_add_u32 s56, s56, 4096
  s_waitcnt vmcnt(7)
  buffer_load_dwordx4 v[120:123], v1, s[24:27], s56 offen nt
  s_add_u32 s56, s56, 4096
  s_waitcnt vmcnt(7)
  buffer_load_dwordx4 v[124:127], v1, s[24:27], s56 offen nt
  s_add_u32 s56, s56, 4096
  s_waitcnt vmcnt(7)
  buffer_load_dwordx4 v[128:131], v1, s[24:27], s56 offen nt
  s_add_u32 s56, s56, 4096
  s_waitcnt vmcnt(7)
  buffer_load_dwordx4 v[132:135], v1, s[24:27], s56 offen nt
  s_add_u32 s56, s56, 4096
  s_waitcnt vmcnt(7)
  buffer_load_dwordx4 v[136:139], v1, s[24:27], s56 offen nt
  s_add_u32 s56, s56, 4096
  s_waitcnt vmcnt(7)
  buffer_load_dwordx4 v[140:143], v1, s[24:27], s56 offen nt
  s_add_u32 s56, s56, 4096
  s_waitcnt vmcnt(7)
  buffer_load_dwordx4 v[144:147], v1, s[24:27], s56 offen nt
  s_add_u32 s56, s56, 4096
  s_waitcnt vmcnt(7)
  buffer_load_dwordx4 v[148:151], v1, s[24:27], s56 offen nt
  s_add_u32 s56, s56, 4096
  s_waitcnt vmcnt(7)
  buffer_load_dwordx4 v[152:155], v1, s[24:27], s56 offen nt
  s_add_u32 s56, s56, 4096
  s_waitcnt vmcnt(7)
  buffer_load_dwordx4 v[156:159], v1, s[24:27], s56 offen nt
  s_add_u32 s56, s56, 4096
  s_waitcnt vmcnt(7)
  buffer_load_dwordx4 v[160:163], v1, s[24:27], s56 offen nt
  s_add_u32 s56, s56, 4096
  s_waitcnt vmcnt(7)
  buffer_load_dwordx4 v[164:167], v1, s[24:27], s56 offen nt
  s_add_u32 s56, s56, 4096
  s_waitcnt vmcnt(7)
  buffer_load_dwordx4 v[168:171], v1, s[24:27], s56 offen nt
  s_add_u32 s56, s56, 4096
  s_waitcnt vmcnt(7)
  buffer_load_dwordx4 v[172:175], v1, s[24:27], s56 offen nt
  s_add_u32 s56, s56, 4096
  s_waitcnt vmcnt(7)
  buffer_load_dwordx4 v[176:179], v1, s[24:27], s56 offen nt
  s_add_u32 s56, s56, 4096
  s_waitcnt vmcnt(7)
  buffer_load_dwordx4 v[180:183], v1, s[24:27], s56 offen nt
  s_add_u32 s56, s56, 4096
  s_waitcnt vmcnt(7)
  buffer_load_dwordx4 v[184:187], v1, s[24:27], s56 offen nt
  s_add_u32 s56, s56, 4096
  s_waitcnt vmcnt(7)
  buffer_load_dwordx4 v[188:191], v1, s[24:27], s56 offen nt
  s_add_u32 s56, s56, 4096
  s_waitcnt vmcnt(7)
  buffer_load_dwordx4 v[192:195], v1, s[24:27], s56 offen nt
  s_add_u32 s56, s56, 4096
  v_mov_b32 v40, 1
  ds_write_b32 v41, v40 offset:34084
  s_waitcnt vmcnt(7)
  buffer_load_dwordx4 v[196:199], v1, s[24:27], s56 offen nt
  s_add_u32 s56, s56, 4096
  s_waitcnt vmcnt(7)
  buffer_load_dwordx4 v[200:203], v1, s[24:27], s56 offen nt
  s_add_u32 s56, s56, 4096
  s_waitcnt vmcnt(7)
  buffer_load_dwordx4 v[204:207], v1, s[24:27], s56 offen nt
  s_add_u32 s56, s56, 4096
  s_waitcnt vmcnt(7)
  buffer_load_dwordx4 v[208:211], v1, s[24:27], s56 offen nt
  s_add_u32 s56, s56, 4096
  s_waitcnt vmcnt(7)
  buffer_load_dwordx4 v[212:215], v1, s[24:27], s56 offen nt
  s_add_u32 s56, s56, 4096
  s_waitcnt vmcnt(7)
  buffer_load_dwordx4 v[216:219], v1, s[24:27], s56 offen nt
  s_add_u32 s56, s56, 4096
  s_waitcnt vmcnt(7)
  buffer_load_dwordx4 v[220:223], v1, s[24:27], s56 offen nt
  s_add_u32 s56, s56, 4096
  s_waitcnt vmcnt(7)
  buffer_load_dwordx4 v[224:227], v1, s[24:27], s56 offen nt
  s_add_u32 s56, s56, 4096
  s_waitcnt vmcnt(7)
  buffer_load_dwordx4 v[228:231], v1, s[24:27], s56 offen nt
  s_add_u32 s56, s56, 4096
  s_waitcnt vmcnt(7)
  buffer_load_dwordx4 v[232:235], v1, s[24:27], s56 offen nt
  s_add_u32 s56, s56, 4096
  s_waitcnt vmcnt(7)
  buffer_load_dwordx4 v[236:239], v1, s[24:27], s56 offen nt
  s_add_u32 s56, s56, 4096
  s_waitcnt vmcnt(7)
  buffer_load_dwordx4 v[240:243], v1, s[24:27], s56 offen nt
  s_add_u32 s56, s56, 4096
  s_waitcnt vmcnt(7)
  buffer_load_dwordx4 v[244:247], v1, s[24:27], s56 offen nt
  s_add_u32 s56, s56, 4096
  s_waitcnt vmcnt(7)
  buffer_load_dwordx4 v[248:251], v1, s[24:27], s56 offen nt
  s_add_u32 s56, s56, 4096
  s_waitcnt vmcnt(7)
  buffer_load_dwordx4 v[252:255], v1, s[24:27], s56 offen nt
  s_add_u32 s56, s56, 4096
  s_waitcnt lgkmcnt(0)
  s_barrier
  ds_read_b128 v[16:19], v6 offset:33792
  ds_read_b32 v42, v41 offset:34088
  s_waitcnt lgkmcnt(0)
  v_dot2_f32_bf16 v20, v64, v16, 0
  v_dot2_f32_bf16 v20, v65, v17, v20
  v_dot2_f32_bf16 v20, v66, v18, v20
  v_dot2_f32_bf16 v20, v67, v19, v20
  s_waitcnt vmcnt(7)
  buffer_load_dwordx4 v[64:67], v1, s[24:27], s56 offen nt
  s_add_u32 s56, s56, 4096
  v_dot2_f32_bf16 v21, v68, v16, 0
  v_dot2_f32_bf16 v21, v69, v17, v21
  v_dot2_f32_bf16 v21, v70, v18, v21
  v_dot2_f32_bf16 v21, v71, v19, v21
  s_waitcnt vmcnt(7)
  buffer_load_dwordx4 v[68:71], v1, s[24:27], s56 offen nt
  s_add_u32 s56, s56, 4096
  v_dot2_f32_bf16 v22, v72, v16, 0
  v_dot2_f32_bf16 v22, v73, v17, v22
  v_dot2_f32_bf16 v22, v74, v18, v22
  v_dot2_f32_bf16 v22, v75, v19, v22
  v_add_f32_dpp v20, v20, v20 row_ror:8 row_mask:0xf bank_mask:0x3
  s_nop 1
  v_add_f32_dpp v20, v21, v21 row_ror:8 row_mask:0xf bank_mask:0xc
  s_waitcnt vmcnt(7)
  buffer_load_dwordx4 v[72:75], v1, s[24:27], s56 offen nt
  s_add_u32 s56, s56, 4096
  v_dot2_f32_bf16 v23, v76, v16, 0
  v_dot2_f32_bf16 v23, v77, v17, v23
  v_dot2_f32_bf16 v23, v78, v18, v23
  v_dot2_f32_bf16 v23, v79, v19, v23
  s_waitcnt vmcnt(7)
  buffer_load_dwordx4 v[76:79], v1, s[24:27], s56 offen nt
  s_add_u32 s56, s56, 4096
  v_dot2_f32_bf16 v24, v80, v16, 0
  v_dot2_f32_bf16 v24, v81, v17, v24
  v_dot2_f32_bf16 v24, v82, v18, v24
  v_dot2_f32_bf16 v24, v83, v19, v24
  v_add_f32_dpp v22, v22, v22 row_ror:8 row_mask:0xf bank_mask:0x3
  s_nop 1
  v_add_f32_dpp v22, v23, v23 row_ror:8 row_mask:0xf bank_mask:0xc
  v_dot2_f32_bf16 v25, v84, v16, 0
  v_dot2_f32_bf16 v25, v85, v17, v25
  v_dot2_f32_bf16 v25, v86, v18, v25
  v_dot2_f32_bf16 v25, v87, v19, v25
  v_add_f32_dpp v20, v20, v20 row_shl:4 row_mask:0xf bank_mask:0x5
  s_nop 1
  v_add_f32_dpp v20, v22, v22 row_shr:4 row_mask:0xf bank_mask:0xa
  v_dot2_f32_bf16 v26, v88, v16, 0
  v_dot2_f32_bf16 v26, v89, v17, v26
  v_dot2_f32_bf16 v26, v90, v18, v26
  v_dot2_f32_bf16 v26, v91, v19, v26
  v_add_f32_dpp v24, v24, v24 row_ror:8 row_mask:0xf bank_mask:0x3
  s_nop 1
  v_add_f32_dpp v24, v25, v25 row_ror:8 row_mask:0xf bank_mask:0xc
  v_dot2_f32_bf16 v27, v92, v16, 0
  v_dot2_f32_bf16 v27, v93, v17, v27
  v_dot2_f32_bf16 v27, v94, v18, v27
  v_dot2_f32_bf16 v27, v95, v19, v27
  s_waitcnt vmcnt(7)
  buffer_load_dwordx4 v[80:83], v1, s[24:27], s56 offen nt
  s_add_u32 s56, s56, 4096
  v_dot2_f32_bf16 v28, v96, v16, 0
  v_dot2_f32_bf16 v28, v97, v17, v28
  v_dot2_f32_bf16 v28, v98, v18, v28
  v_dot2_f32_bf16 v28, v99, v19, v28
  v_add_f32_dpp v26, v26, v26 row_ror:8 row_mask:0xf bank_mask:0x3
  s_nop 1
  v_add_f32_dpp v26, v27, v27 row_ror:8 row_mask:0xf bank_mask:0xc
  v_dot2_f32_bf16 v29, v100, v16, 0
  v_dot2_f32_bf16 v29, v101, v17, v29
  v_dot2_f32_bf16 v29, v102, v18, v29
  v_dot2_f32_bf16 v29, v103, v19, v29
  v_add_f32_dpp v24, v24, v24 row_shl:4 row_mask:0xf bank_mask:0x5
  s_nop 1
  v_add_f32_dpp v24, v26, v26 row_shr:4 row_mask:0xf bank_mask:0xa
  v_dot2_f32_bf16 v30, v104, v16, 0
  v_dot2_f32_bf16 v30, v105, v17, v30
  v_dot2_f32_bf16 v30, v106, v18, v30
  v_dot2_f32_bf16 v30, v107, v19, v30
  v_add_f32_dpp v28, v28, v28 row_ror:8 row_mask:0xf bank_mask:0x3
  s_nop 1
  v_add_f32_dpp v28, v29, v29 row_ror:8 row_mask:0xf bank_mask:0xc
  v_dot2_f32_bf16 v31, v108, v16, 0
  v_dot2_f32_bf16 v31, v109, v17, v31
  v_dot2_f32_bf16 v31, v110, v18, v31
  v_dot2_f32_bf16 v31, v111, v19, v31
  s_waitcnt vmcnt(7)
  buffer_load_dwordx4 v[84:87], v1, s[24:27], s56 offen nt
  s_add_u32 s56, s56, 4096
  v_dot2_f32_bf16 v32, v112, v16, 0
  v_dot2_f32_bf16 v32, v113, v17, v32
  v_dot2_f32_bf16 v32, v114, v18, v32
  v_dot2_f32_bf16 v32, v115, v19, v32
  v_add_f32_dpp v30, v30, v30 row_ror:8 row_mask:0xf bank_mask:0x3
  s_nop 1
  v_add_f32_dpp v30, v31, v31 row_ror:8 row_mask:0xf bank_mask:0xc
  v_dot2_f32_bf16 v33, v116, v16, 0
  v_dot2_f32_bf16 v33, v117, v17, v33
  v_dot2_f32_bf16 v33, v118, v18, v33
  v_dot2_f32_bf16 v33, v119, v19, v33
  v_add_f32_dpp v28, v28, v28 row_shl:4 row_mask:0xf bank_mask:0x5
  s_nop 1
  v_add_f32_dpp v28, v30, v30 row_shr:4 row_mask:0xf bank_mask:0xa
  v_dot2_f32_bf16 v34, v120, v16, 0
  v_dot2_f32_bf16 v34, v121, v17, v34
  v_dot2_f32_bf16 v34, v122, v18, v34
  v_dot2_f32_bf16 v34, v123, v19, v34
  v_add_f32_dpp v32, v32, v32 row_ror:8 row_mask:0xf bank_mask:0x3
  s_nop 1
  v_add_f32_dpp v32, v33, v33 row_ror:8 row_mask:0xf bank_mask:0xc
  v_dot2_f32_bf16 v35, v124, v16, 0
  v_dot2_f32_bf16 v35, v125, v17, v35
  v_dot2_f32_bf16 v35, v126, v18, v35
  v_dot2_f32_bf16 v35, v127, v19, v35
  v_add_f32_dpp v34, v34, v34 row_ror:8 row_mask:0xf bank_mask:0x3
  s_nop 1
  v_add_f32_dpp v34, v35, v35 row_ror:8 row_mask:0xf bank_mask:0xc
  v_add_f32_dpp v32, v32, v32 row_shl:4 row_mask:0xf bank_mask:0x5
  s_nop 1
  v_add_f32_dpp v32, v34, v34 row_shr:4 row_mask:0xf bank_mask:0xa
  v_add_f32_dpp v20, v20, v20 quad_perm:[1,0,3,2] row_mask:0xf bank_mask:0xf
  v_add_f32_dpp v24, v24, v24 quad_perm:[1,0,3,2] row_mask:0xf bank_mask:0xf
  v_add_f32_dpp v28, v28, v28 quad_perm:[1,0,3,2] row_mask:0xf bank_mask:0xf
  v_add_f32_dpp v32, v32, v32 quad_perm:[1,0,3,2] row_mask:0xf bank_mask:0xf
  v_add_f32_dpp v44, v20, v20 quad_perm:[2,3,0,1] row_mask:0xf bank_mask:0xf
  v_add_f32_dpp v45, v24, v24 quad_perm:[2,3,0,1] row_mask:0xf bank_mask:0xf
  v_add_f32_dpp v46, v28, v28 quad_perm:[2,3,0,1] row_mask:0xf bank_mask:0xf
  v_add_f32_dpp v47, v32, v32 quad_perm:[2,3,0,1] row_mask:0xf bank_mask:0xf
  v_mul_f32 v44, s61, v44
  v_mul_f32 v45, s61, v45
  v_mul_f32 v46, s61, v46
  v_mul_f32 v47, s61, v47
  ds_write_b128 v7, v[44:47] offset:0
  v_max3_f32 v50, v48, v44, v45
  v_max3_f32 v50, v50, v46, v47
  v_sub_f32 v51, v48, v50
  v_sub_f32 v52, v44, v50
  v_sub_f32 v53, v45, v50
  v_sub_f32 v54, v46, v50
  v_sub_f32 v55, v47, v50
  v_exp_f32 v51, v51
  v_exp_f32 v52, v52
  v_exp_f32 v53, v53
  v_exp_f32 v54, v54
  v_exp_f32 v55, v55
  v_mov_b32 v48, v50
  v_add_f32 v52, v52, v53
  v_add_f32 v54, v54, v55
  v_add_f32 v52, v52, v54
  v_fma_f32 v49, v49, v51, v52
  s_waitcnt vmcnt(7)
  buffer_load_dwordx4 v[88:91], v1, s[24:27], s56 offen nt
  s_add_u32 s56, s56, 4096
  v_dot2_f32_bf16 v20, v128, v16, 0
  v_dot2_f32_bf16 v20, v129, v17, v20
  v_dot2_f32_bf16 v20, v130, v18, v20
  v_dot2_f32_bf16 v20, v131, v19, v20
  v_dot2_f32_bf16 v21, v132, v16, 0
  v_dot2_f32_bf16 v21, v133, v17, v21
  v_dot2_f32_bf16 v21, v134, v18, v21
  v_dot2_f32_bf16 v21, v135, v19, v21
  v_dot2_f32_bf16 v22, v136, v16, 0
  v_dot2_f32_bf16 v22, v137, v17, v22
  v_dot2_f32_bf16 v22, v138, v18, v22
  v_dot2_f32_bf16 v22, v139, v19, v22
  v_add_f32_dpp v20, v20, v20 row_ror:8 row_mask:0xf bank_mask:0x3
  s_nop 1
  v_add_f32_dpp v20, v21, v21 row_ror:8 row_mask:0xf bank_mask:0xc
  v_dot2_f32_bf16 v23, v140, v16, 0
  v_dot2_f32_bf16 v23, v141, v17, v23
  v_dot2_f32_bf16 v23, v142, v18, v23
  v_dot2_f32_bf16 v23, v143, v19, v23
  s_waitcnt vmcnt(7)
  buffer_load_dwordx4 v[92:95], v1, s[24:27], s56 offen nt
  s_add_u32 s56, s56, 4096
  v_dot2_f32_bf16 v24, v144, v16, 0
  v_dot2_f32_bf16 v24, v145, v17, v24
  v_dot2_f32_bf16 v24, v146, v18, v24
  v_dot2_f32_bf16 v24, v147, v19, v24
  v_add_f32_dpp v22, v22, v22 row_ror:8 row_mask:0xf bank_mask:0x3
  s_nop 1
  v_add_f32_dpp v22, v23, v23 row_ror:8 row_mask:0xf bank_mask:0xc
  v_dot2_f32_bf16 v25, v148, v16, 0
  v_dot2_f32_bf16 v25, v149, v17, v25
  v_dot2_f32_bf16 v25, v150, v18, v25
  v_dot2_f32_bf16 v25, v151, v19, v25
  v_add_f32_dpp v20, v20, v20 row_shl:4 row_mask:0xf bank_mask:0x5
  s_nop 1
  v_add_f32_dpp v20, v22, v22 row_shr:4 row_mask:0xf bank_mask:0xa
  v_dot2_f32_bf16 v26, v152, v16, 0
  v_dot2_f32_bf16 v26, v153, v17, v26
  v_dot2_f32_bf16 v26, v154, v18, v26
  v_dot2_f32_bf16 v26, v155, v19, v26
  v_add_f32_dpp v24, v24, v24 row_ror:8 row_mask:0xf bank_mask:0x3
  s_nop 1
  v_add_f32_dpp v24, v25, v25 row_ror:8 row_mask:0xf bank_mask:0xc
  v_dot2_f32_bf16 v27, v156, v16, 0
  v_dot2_f32_bf16 v27, v157, v17, v27
  v_dot2_f32_bf16 v27, v158, v18, v27
  v_dot2_f32_bf16 v27, v159, v19, v27
  s_waitcnt vmcnt(7)
  buffer_load_dwordx4 v[96:99], v1, s[24:27], s56 offen nt
  s_add_u32 s56, s56, 4096
  v_dot2_f32_bf16 v28, v160, v16, 0
  v_dot2_f32_bf16 v28, v161, v17, v28
  v_dot2_f32_bf16 v28, v162, v18, v28
  v_dot2_f32_bf16 v28, v163, v19, v28
  v_add_f32_dpp v26, v26, v26 row_ror:8 row_mask:0xf bank_mask:0x3
  s_nop 1
  v_add_f32_dpp v26, v27, v27 row_ror:8 row_mask:0xf bank_mask:0xc
  v_dot2_f32_bf16 v29, v164, v16, 0
  v_dot2_f32_bf16 v29, v165, v17, v29
  v_dot2_f32_bf16 v29, v166, v18, v29
  v_dot2_f32_bf16 v29, v167, v19, v29
  v_add_f32_dpp v24, v24, v24 row_shl:4 row_mask:0xf bank_mask:0x5
  s_nop 1
  v_add_f32_dpp v24, v26, v26 row_shr:4 row_mask:0xf bank_mask:0xa
  v_dot2_f32_bf16 v30, v168, v16, 0
  v_dot2_f32_bf16 v30, v169, v17, v30
  v_dot2_f32_bf16 v30, v170, v18, v30
  v_dot2_f32_bf16 v30, v171, v19, v30
  v_add_f32_dpp v28, v28, v28 row_ror:8 row_mask:0xf bank_mask:0x3
  s_nop 1
  v_add_f32_dpp v28, v29, v29 row_ror:8 row_mask:0xf bank_mask:0xc
  v_dot2_f32_bf16 v31, v172, v16, 0
  v_dot2_f32_bf16 v31, v173, v17, v31
  v_dot2_f32_bf16 v31, v174, v18, v31
  v_dot2_f32_bf16 v31, v175, v19, v31
  s_waitcnt vmcnt(7)
  buffer_load_dwordx4 v[100:103], v1, s[24:27], s56 offen nt
  s_add_u32 s56, s56, 4096
  v_dot2_f32_bf16 v32, v176, v16, 0
  v_dot2_f32_bf16 v32, v177, v17, v32
  v_dot2_f32_bf16 v32, v178, v18, v32
  v_dot2_f32_bf16 v32, v179, v19, v32
  v_add_f32_dpp v30, v30, v30 row_ror:8 row_mask:0xf bank_mask:0x3
  s_nop 1
  v_add_f32_dpp v30, v31, v31 row_ror:8 row_mask:0xf bank_mask:0xc
  v_dot2_f32_bf16 v33, v180, v16, 0
  v_dot2_f32_bf16 v33, v181, v17, v33
  v_dot2_f32_bf16 v33, v182, v18, v33
  v_dot2_f32_bf16 v33, v183, v19, v33
  v_add_f32_dpp v28, v28, v28 row_shl:4 row_mask:0xf bank_mask:0x5
  s_nop 1
  v_add_f32_dpp v28, v30, v30 row_shr:4 row_mask:0xf bank_mask:0xa
  v_dot2_f32_bf16 v34, v184, v16, 0
  v_dot2_f32_bf16 v34, v185, v17, v34
  v_dot2_f32_bf16 v34, v186, v18, v34
  v_dot2_f32_bf16 v34, v187, v19, v34
  v_add_f32_dpp v32, v32, v32 row_ror:8 row_mask:0xf bank_mask:0x3
  s_nop 1
  v_add_f32_dpp v32, v33, v33 row_ror:8 row_mask:0xf bank_mask:0xc
  v_dot2_f32_bf16 v35, v188, v16, 0
  v_dot2_f32_bf16 v35, v189, v17, v35
  v_dot2_f32_bf16 v35, v190, v18, v35
  v_dot2_f32_bf16 v35, v191, v19, v35
  v_add_f32_dpp v34, v34, v34 row_ror:8 row_mask:0xf bank_mask:0x3
  s_nop 1
  v_add_f32_dpp v34, v35, v35 row_ror:8 row_mask:0xf bank_mask:0xc
  v_add_f32_dpp v32, v32, v32 row_shl:4 row_mask:0xf bank_mask:0x5
  s_nop 1
  v_add_f32_dpp v32, v34, v34 row_shr:4 row_mask:0xf bank_mask:0xa
  v_add_f32_dpp v20, v20, v20 quad_perm:[1,0,3,2] row_mask:0xf bank_mask:0xf
  v_add_f32_dpp v24, v24, v24 quad_perm:[1,0,3,2] row_mask:0xf bank_mask:0xf
  v_add_f32_dpp v28, v28, v28 quad_perm:[1,0,3,2] row_mask:0xf bank_mask:0xf
  v_add_f32_dpp v32, v32, v32 quad_perm:[1,0,3,2] row_mask:0xf bank_mask:0xf
  v_add_f32_dpp v44, v20, v20 quad_perm:[2,3,0,1] row_mask:0xf bank_mask:0xf
  v_add_f32_dpp v45, v24, v24 quad_perm:[2,3,0,1] row_mask:0xf bank_mask:0xf
  v_add_f32_dpp v46, v28, v28 quad_perm:[2,3,0,1] row_mask:0xf bank_mask:0xf
  v_add_f32_dpp v47, v32, v32 quad_perm:[2,3,0,1] row_mask:0xf bank_mask:0xf
  v_mul_f32 v44, s61, v44
  v_mul_f32 v45, s61, v45
  v_mul_f32 v46, s61, v46
  v_mul_f32 v47, s61, v47
  ds_write_b128 v7, v[44:47] offset:1024
  v_max3_f32 v50, v48, v44, v45
  v_max3_f32 v50, v50, v46, v47
  v_sub_f32 v51, v48, v50
  v_sub_f32 v52, v44, v50
  v_sub_f32 v53, v45, v50
  v_sub_f32 v54, v46, v50
  v_sub_f32 v55, v47, v50
  v_exp_f32 v51, v51
  v_exp_f32 v52, v52
  v_exp_f32 v53, v53
  v_exp_f32 v54, v54
  v_exp_f32 v55, v55
  v_mov_b32 v48, v50
  v_add_f32 v52, v52, v53
  v_add_f32 v54, v54, v55
  v_add_f32 v52, v52, v54
  v_fma_f32 v49, v49, v51, v52
  s_waitcnt vmcnt(7)
  buffer_load_dwordx4 v[104:107], v1, s[24:27], s56 offen nt
  s_add_u32 s56, s56, 4096
  v_dot2_f32_bf16 v20, v192, v16, 0
  v_dot2_f32_bf16 v20, v193, v17, v20
  v_dot2_f32_bf16 v20, v194, v18, v20
  v_dot2_f32_bf16 v20, v195, v19, v20
  v_dot2_f32_bf16 v21, v196, v16, 0
  v_dot2_f32_bf16 v21, v197, v17, v21
  v_dot2_f32_bf16 v21, v198, v18, v21
  v_dot2_f32_bf16 v21, v199, v19, v21
  v_dot2_f32_bf16 v22, v200, v16, 0
  v_dot2_f32_bf16 v22, v201, v17, v22
  v_dot2_f32_bf16 v22, v202, v18, v22
  v_dot2_f32_bf16 v22, v203, v19, v22
  v_add_f32_dpp v20, v20, v20 row_ror:8 row_mask:0xf bank_mask:0x3
  s_nop 1
  v_add_f32_dpp v20, v21, v21 row_ror:8 row_mask:0xf bank_mask:0xc
  v_dot2_f32_bf16 v23, v204, v16, 0
  v_dot2_f32_bf16 v23, v205, v17, v23
  v_dot2_f32_bf16 v23, v206, v18, v23
  v_dot2_f32_bf16 v23, v207, v19, v23
  s_waitcnt vmcnt(7)
  buffer_load_dwordx4 v[108:111], v1, s[24:27], s56 offen nt
  s_add_u32 s56, s56, 4096
  v_dot2_f32_bf16 v24, v208, v16, 0
  v_dot2_f32_bf16 v24, v209, v17, v24
  v_dot2_f32_bf16 v24, v210, v18, v24
  v_dot2_f32_bf16 v24, v211, v19, v24
  v_add_f32_dpp v22, v22, v22 row_ror:8 row_mask:0xf bank_mask:0x3
  s_nop 1
  v_add_f32_dpp v22, v23, v23 row_ror:8 row_mask:0xf bank_mask:0xc
  v_dot2_f32_bf16 v25, v212, v16, 0
  v_dot2_f32_bf16 v25, v213, v17, v25
  v_dot2_f32_bf16 v25, v214, v18, v25
  v_dot2_f32_bf16 v25, v215, v19, v25
  v_add_f32_dpp v20, v20, v20 row_shl:4 row_mask:0xf bank_mask:0x5
  s_nop 1
  v_add_f32_dpp v20, v22, v22 row_shr:4 row_mask:0xf bank_mask:0xa
  v_dot2_f32_bf16 v26, v216, v16, 0
  v_dot2_f32_bf16 v26, v217, v17, v26
  v_dot2_f32_bf16 v26, v218, v18, v26
  v_dot2_f32_bf16 v26, v219, v19, v26
  v_add_f32_dpp v24, v24, v24 row_ror:8 row_mask:0xf bank_mask:0x3
  s_nop 1
  v_add_f32_dpp v24, v25, v25 row_ror:8 row_mask:0xf bank_mask:0xc
  v_dot2_f32_bf16 v27, v220, v16, 0
  v_dot2_f32_bf16 v27, v221, v17, v27
  v_dot2_f32_bf16 v27, v222, v18, v27
  v_dot2_f32_bf16 v27, v223, v19, v27
  s_waitcnt vmcnt(7)
  buffer_load_dwordx4 v[112:115], v1, s[24:27], s56 offen nt
  s_add_u32 s56, s56, 4096
  v_dot2_f32_bf16 v28, v224, v16, 0
  v_dot2_f32_bf16 v28, v225, v17, v28
  v_dot2_f32_bf16 v28, v226, v18, v28
  v_dot2_f32_bf16 v28, v227, v19, v28
  v_add_f32_dpp v26, v26, v26 row_ror:8 row_mask:0xf bank_mask:0x3
  s_nop 1
  v_add_f32_dpp v26, v27, v27 row_ror:8 row_mask:0xf bank_mask:0xc
  v_dot2_f32_bf16 v29, v228, v16, 0
  v_dot2_f32_bf16 v29, v229, v17, v29
  v_dot2_f32_bf16 v29, v230, v18, v29
  v_dot2_f32_bf16 v29, v231, v19, v29
  v_add_f32_dpp v24, v24, v24 row_shl:4 row_mask:0xf bank_mask:0x5
  s_nop 1
  v_add_f32_dpp v24, v26, v26 row_shr:4 row_mask:0xf bank_mask:0xa
  v_dot2_f32_bf16 v30, v232, v16, 0
  v_dot2_f32_bf16 v30, v233, v17, v30
  v_dot2_f32_bf16 v30, v234, v18, v30
  v_dot2_f32_bf16 v30, v235, v19, v30
  v_add_f32_dpp v28, v28, v28 row_ror:8 row_mask:0xf bank_mask:0x3
  s_nop 1
  v_add_f32_dpp v28, v29, v29 row_ror:8 row_mask:0xf bank_mask:0xc
  v_dot2_f32_bf16 v31, v236, v16, 0
  v_dot2_f32_bf16 v31, v237, v17, v31
  v_dot2_f32_bf16 v31, v238, v18, v31
  v_dot2_f32_bf16 v31, v239, v19, v31
  s_waitcnt vmcnt(7)
  buffer_load_dwordx4 v[116:119], v1, s[24:27], s56 offen nt
  s_add_u32 s56, s56, 4096
  v_dot2_f32_bf16 v32, v240, v16, 0
  v_dot2_f32_bf16 v32, v241, v17, v32
  v_dot2_f32_bf16 v32, v242, v18, v32
  v_dot2_f32_bf16 v32, v243, v19, v32
  v_add_f32_dpp v30, v30, v30 row_ror:8 row_mask:0xf bank_mask:0x3
  s_nop 1
  v_add_f32_dpp v30, v31, v31 row_ror:8 row_mask:0xf bank_mask:0xc
  v_dot2_f32_bf16 v33, v244, v16, 0
  v_dot2_f32_bf16 v33, v245, v17, v33
  v_dot2_f32_bf16 v33, v246, v18, v33
  v_dot2_f32_bf16 v33, v247, v19, v33
  v_add_f32_dpp v28, v28, v28 row_shl:4 row_mask:0xf bank_mask:0x5
  s_nop 1
  v_add_f32_dpp v28, v30, v30 row_shr:4 row_mask:0xf bank_mask:0xa
  v_dot2_f32_bf16 v34, v248, v16, 0
  v_dot2_f32_bf16 v34, v249, v17, v34
  v_dot2_f32_bf16 v34, v250, v18, v34
  v_dot2_f32_bf16 v34, v251, v19, v34
  v_add_f32_dpp v32, v32, v32 row_ror:8 row_mask:0xf bank_mask:0x3
  s_nop 1
  v_add_f32_dpp v32, v33, v33 row_ror:8 row_mask:0xf bank_mask:0xc
  v_dot2_f32_bf16 v35, v252, v16, 0
  v_dot2_f32_bf16 v35, v253, v17, v35
  v_dot2_f32_bf16 v35, v254, v18, v35
  v_dot2_f32_bf16 v35, v255, v19, v35
  v_add_f32_dpp v34, v34, v34 row_ror:8 row_mask:0xf bank_mask:0x3
  s_nop 1
  v_add_f32_dpp v34, v35, v35 row_ror:8 row_mask:0xf bank_mask:0xc
  v_add_f32_dpp v32, v32, v32 row_shl:4 row_mask:0xf bank_mask:0x5
  s_nop 1
  v_add_f32_dpp v32, v34, v34 row_shr:4 row_mask:0xf bank_mask:0xa
  v_add_f32_dpp v20, v20, v20 quad_perm:[1,0,3,2] row_mask:0xf bank_mask:0xf
  v_add_f32_dpp v24, v24, v24 quad_perm:[1,0,3,2] row_mask:0xf bank_mask:0xf
  v_add_f32_dpp v28, v28, v28 quad_perm:[1,0,3,2] row_mask:0xf bank_mask:0xf
  v_add_f32_dpp v32, v32, v32 quad_perm:[1,0,3,2] row_mask:0xf bank_mask:0xf
  v_add_f32_dpp v44, v20, v20 quad_perm:[2,3,0,1] row_mask:0xf bank_mask:0xf
  v_add_f32_dpp v45, v24, v24 quad_perm:[2,3,0,1] row_mask:0xf bank_mask:0xf
  v_add_f32_dpp v46, v28, v28 quad_perm:[2,3,0,1] row_mask:0xf bank_mask:0xf
  v_add_f32_dpp v47, v32, v32 quad_perm:[2,3,0,1] row_mask:0xf bank_mask:0xf
  v_mul_f32 v44, s61, v44
  v_mul_f32 v45, s61, v45
  v_mul_f32 v46, s61, v46
  v_mul_f32 v47, s61, v47
  ds_write_b128 v7, v[44:47] offset:2048
  v_max3_f32 v50, v48, v44, v45
  v_max3_f32 v50, v50, v46, v47
  v_sub_f32 v51, v48, v50
  v_sub_f32 v52, v44, v50
  v_sub_f32 v53, v45, v50
  v_sub_f32 v54, v46, v50
  v_sub_f32 v55, v47, v50
  v_exp_f32 v51, v51
  v_exp_f32 v52, v52
  v_exp_f32 v53, v53
  v_exp_f32 v54, v54
  v_exp_f32 v55, v55
  v_mov_b32 v48, v50
  v_add_f32 v52, v52, v53
  v_add_f32 v54, v54, v55
  v_add_f32 v52, v52, v54
  v_fma_f32 v49, v49, v51, v52
  s_waitcnt vmcnt(7)
  buffer_load_dwordx4 v[120:123], v1, s[24:27], s56 offen nt
  s_add_u32 s56, s56, 4096
  v_dot2_f32_bf16 v20, v64, v16, 0
  v_dot2_f32_bf16 v20, v65, v17, v20
  v_dot2_f32_bf16 v20, v66, v18, v20
  v_dot2_f32_bf16 v20, v67, v19, v20
  v_dot2_f32_bf16 v21, v68, v16, 0
  v_dot2_f32_bf16 v21, v69, v17, v21
  v_dot2_f32_bf16 v21, v70, v18, v21
  v_dot2_f32_bf16 v21, v71, v19, v21
  v_dot2_f32_bf16 v22, v72, v16, 0
  v_dot2_f32_bf16 v22, v73, v17, v22
  v_dot2_f32_bf16 v22, v74, v18, v22
  v_dot2_f32_bf16 v22, v75, v19, v22
  v_add_f32_dpp v20, v20, v20 row_ror:8 row_mask:0xf bank_mask:0x3
  s_nop 1
  v_add_f32_dpp v20, v21, v21 row_ror:8 row_mask:0xf bank_mask:0xc
  v_dot2_f32_bf16 v23, v76, v16, 0
  v_dot2_f32_bf16 v23, v77, v17, v23
  v_dot2_f32_bf16 v23, v78, v18, v23
  v_dot2_f32_bf16 v23, v79, v19, v23
  s_waitcnt vmcnt(7)
  buffer_load_dwordx4 v[124:127], v1, s[24:27], s56 offen nt
  s_add_u32 s56, s56, 4096
  v_dot2_f32_bf16 v24, v80, v16, 0
  v_dot2_f32_bf16 v24, v81, v17, v24
  v_dot2_f32_bf16 v24, v82, v18, v24
  v_dot2_f32_bf16 v24, v83, v19, v24
  v_add_f32_dpp v22, v22, v22 row_ror:8 row_mask:0xf bank_mask:0x3
  s_nop 1
  v_add_f32_dpp v22, v23, v23 row_ror:8 row_mask:0xf bank_mask:0xc
  v_dot2_f32_bf16 v25, v84, v16, 0
  v_dot2_f32_bf16 v25, v85, v17, v25
  v_dot2_f32_bf16 v25, v86, v18, v25
  v_dot2_f32_bf16 v25, v87, v19, v25
  v_add_f32_dpp v20, v20, v20 row_shl:4 row_mask:0xf bank_mask:0x5
  s_nop 1
  v_add_f32_dpp v20, v22, v22 row_shr:4 row_mask:0xf bank_mask:0xa
  v_dot2_f32_bf16 v26, v88, v16, 0
  v_dot2_f32_bf16 v26, v89, v17, v26
  v_dot2_f32_bf16 v26, v90, v18, v26
  v_dot2_f32_bf16 v26, v91, v19, v26
  v_add_f32_dpp v24, v24, v24 row_ror:8 row_mask:0xf bank_mask:0x3
  s_nop 1
  v_add_f32_dpp v24, v25, v25 row_ror:8 row_mask:0xf bank_mask:0xc
  v_dot2_f32_bf16 v27, v92, v16, 0
  v_dot2_f32_bf16 v27, v93, v17, v27
  v_dot2_f32_bf16 v27, v94, v18, v27
  v_dot2_f32_bf16 v27, v95, v19, v27
  s_waitcnt vmcnt(7)
  buffer_load_dwordx4 v[64:67], v1, s[24:27], s56 offen nt
  s_add_u32 s56, s56, 4096
  v_dot2_f32_bf16 v28, v96, v16, 0
  v_dot2_f32_bf16 v28, v97, v17, v28
  v_dot2_f32_bf16 v28, v98, v18, v28
  v_dot2_f32_bf16 v28, v99, v19, v28
  v_add_f32_dpp v26, v26, v26 row_ror:8 row_mask:0xf bank_mask:0x3
  s_nop 1
  v_add_f32_dpp v26, v27, v27 row_ror:8 row_mask:0xf bank_mask:0xc
  s_waitcnt vmcnt(7)
  buffer_load_dwordx4 v[68:71], v1, s[24:27], s56 offen nt
  s_add_u32 s56, s56, 4096
  buffer_load_dwordx4 v[128:131], v3, s[36:39], s58 offen nt
  s_add_u32 s58, s58, 4096
  v_dot2_f32_bf16 v29, v100, v16, 0
  v_dot2_f32_bf16 v29, v101, v17, v29
  v_dot2_f32_bf16 v29, v102, v18, v29
  v_dot2_f32_bf16 v29, v103, v19, v29
  v_add_f32_dpp v24, v24, v24 row_shl:4 row_mask:0xf bank_mask:0x5
  s_nop 1
  v_add_f32_dpp v24, v26, v26 row_shr:4 row_mask:0xf bank_mask:0xa
  s_waitcnt vmcnt(8)
  buffer_load_dwordx4 v[72:75], v1, s[24:27], s56 offen nt
  s_add_u32 s56, s56, 4096
  v_dot2_f32_bf16 v30, v104, v16, 0
  v_dot2_f32_bf16 v30, v105, v17, v30
  v_dot2_f32_bf16 v30, v106, v18, v30
  v_dot2_f32_bf16 v30, v107, v19, v30
  v_add_f32_dpp v28, v28, v28 row_ror:8 row_mask:0xf bank_mask:0x3
  s_nop 1
  v_add_f32_dpp v28, v29, v29 row_ror:8 row_mask:0xf bank_mask:0xc
  s_waitcnt vmcnt(8)
  buffer_load_dwordx4 v[76:79], v1, s[24:27], s56 offen nt
  s_add_u32 s56, s56, 4096
  buffer_load_dwordx4 v[132:135], v3, s[36:39], s58 offen nt
  s_add_u32 s58, s58, 4096
  v_dot2_f32_bf16 v31, v108, v16, 0
  v_dot2_f32_bf16 v31, v109, v17, v31
  v_dot2_f32_bf16 v31, v110, v18, v31
  v_dot2_f32_bf16 v31, v111, v19, v31
  s_waitcnt vmcnt(9)
  buffer_load_dwordx4 v[80:83], v1, s[24:27], s56 offen nt
  s_add_u32 s56, s56, 4096
  v_dot2_f32_bf16 v32, v112, v16, 0
  v_dot2_f32_bf16 v32, v113, v17, v32
  v_dot2_f32_bf16 v32, v114, v18, v32
  v_dot2_f32_bf16 v32, v115, v19, v32
  v_add_f32_dpp v30, v30, v30 row_ror:8 row_mask:0xf bank_mask:0x3
  s_nop 1
  v_add_f32_dpp v30, v31, v31 row_ror:8 row_mask:0xf bank_mask:0xc
  s_waitcnt vmcnt(9)
  buffer_load_dwordx4 v[84:87], v1, s[24:27], s56 offen nt
  s_add_u32 s56, s56, 4096
  buffer_load_dwordx4 v[136:139], v3, s[36:39], s58 offen nt
  s_add_u32 s58, s58, 4096
  v_dot2_f32_bf16 v33, v116, v16, 0
  v_dot2_f32_bf16 v33, v117, v17, v33
  v_dot2_f32_bf16 v33, v118, v18, v33
  v_dot2_f32_bf16 v33, v119, v19, v33
  v_add_f32_dpp v28, v28, v28 row_shl:4 row_mask:0xf bank_mask:0x5
  s_nop 1
  v_add_f32_dpp v28, v30, v30 row_shr:4 row_mask:0xf bank_mask:0xa
  s_waitcnt vmcnt(10)
  buffer_load_dwordx4 v[88:91], v1, s[24:27], s56 offen nt
  s_add_u32 s56, s56, 4096
  v_dot2_f32_bf16 v34, v120, v16, 0
  v_dot2_f32_bf16 v34, v121, v17, v34
  v_dot2_f32_bf16 v34, v122, v18, v34
  v_dot2_f32_bf16 v34, v123, v19, v34
  v_add_f32_dpp v32, v32, v32 row_ror:8 row_mask:0xf bank_mask:0x3
  s_nop 1
  v_add_f32_dpp v32, v33, v33 row_ror:8 row_mask:0xf bank_mask:0xc
  s_waitcnt vmcnt(10)
  buffer_load_dwordx4 v[92:95], v1, s[24:27], s56 offen nt
  s_add_u32 s56, s56, 4096
  buffer_load_dwordx4 v[140:143], v3, s[36:39], s58 offen nt
  s_add_u32 s58, s58, 4096
  v_dot2_f32_bf16 v35, v124, v16, 0
  v_dot2_f32_bf16 v35, v125, v17, v35
  v_dot2_f32_bf16 v35, v126, v18, v35
  v_dot2_f32_bf16 v35, v127, v19, v35
  v_add_f32_dpp v34, v34, v34 row_ror:8 row_mask:0xf bank_mask:0x3
  s_nop 1
  v_add_f32_dpp v34, v35, v35 row_ror:8 row_mask:0xf bank_mask:0xc
  v_add_f32_dpp v32, v32, v32 row_shl:4 row_mask:0xf bank_mask:0x5
  s_nop 1
  v_add_f32_dpp v32, v34, v34 row_shr:4 row_mask:0xf bank_mask:0xa
  v_add_f32_dpp v20, v20, v20 quad_perm:[1,0,3,2] row_mask:0xf bank_mask:0xf
  v_add_f32_dpp v24, v24, v24 quad_perm:[1,0,3,2] row_mask:0xf bank_mask:0xf
  v_add_f32_dpp v28, v28, v28 quad_perm:[1,0,3,2] row_mask:0xf bank_mask:0xf
  v_add_f32_dpp v32, v32, v32 quad_perm:[1,0,3,2] row_mask:0xf bank_mask:0xf
  v_add_f32_dpp v44, v20, v20 quad_perm:[2,3,0,1] row_mask:0xf bank_mask:0xf
  v_add_f32_dpp v45, v24, v24 quad_perm:[2,3,0,1] row_mask:0xf bank_mask:0xf
  v_add_f32_dpp v46, v28, v28 quad_perm:[2,3,0,1] row_mask:0xf bank_mask:0xf
  v_add_f32_dpp v47, v32, v32 quad_perm:[2,3,0,1] row_mask:0xf bank_mask:0xf
  v_mul_f32 v44, s61, v44
  v_mul_f32 v45, s61, v45
  v_mul_f32 v46, s61, v46
  v_mul_f32 v47, s61, v47
  ds_write_b128 v7, v[44:47] offset:3072
  v_max3_f32 v50, v48, v44, v45
  v_max3_f32 v50, v50, v46, v47
  v_sub_f32 v51, v48, v50
  v_sub_f32 v52, v44, v50
  v_sub_f32 v53, v45, v50
  v_sub_f32 v54, v46, v50
  v_sub_f32 v55, v47, v50
  v_exp_f32 v51, v51
  v_exp_f32 v52, v52
  v_exp_f32 v53, v53
  v_exp_f32 v54, v54
  v_exp_f32 v55, v55
  v_mov_b32 v48, v50
  v_add_f32 v52, v52, v53
  v_add_f32 v54, v54, v55
  v_add_f32 v52, v52, v54
  v_fma_f32 v49, v49, v51, v52
  s_waitcnt vmcnt(11)
  buffer_load_dwordx4 v[96:99], v1, s[24:27], s56 offen nt
  s_add_u32 s56, s56, 4096
  v_dot2_f32_bf16 v20, v64, v16, 0
  v_dot2_f32_bf16 v20, v65, v17, v20
  v_dot2_f32_bf16 v20, v66, v18, v20
  v_dot2_f32_bf16 v20, v67, v19, v20
  s_waitcnt vmcnt(11)
  buffer_load_dwordx4 v[100:103], v1, s[24:27], s56 offen nt
  s_add_u32 s56, s56, 4096
  buffer_load_dwordx4 v[144:147], v3, s[36:39], s58 offen nt
  s_add_u32 s58, s58, 4096
  v_dot2_f32_bf16 v21, v68, v16, 0
  v_dot2_f32_bf16 v21, v69, v17, v21
  v_dot2_f32_bf16 v21, v70, v18, v21
  v_dot2_f32_bf16 v21, v71, v19, v21
  s_waitcnt vmcnt(11)
  buffer_load_dwordx4 v[104:107], v1, s[24:27], s56 offen nt
  s_add_u32 s56, s56, 4096
  v_dot2_f32_bf16 v22, v72, v16, 0
  v_dot2_f32_bf16 v22, v73, v17, v22
  v_dot2_f32_bf16 v22, v74, v18, v22
  v_dot2_f32_bf16 v22, v75, v19, v22
  v_add_f32_dpp v20, v20, v20 row_ror:8 row_mask:0xf bank_mask:0x3
  s_nop 1
  v_add_f32_dpp v20, v21, v21 row_ror:8 row_mask:0xf bank_mask:0xc
  s_waitcnt vmcnt(11)
  buffer_load_dwordx4 v[108:111], v1, s[24:27], s56 offen nt
  s_add_u32 s56, s56, 4096
  buffer_load_dwordx4 v[148:151], v3, s[36:39], s58 offen nt
  s_add_u32 s58, s58, 4096
  v_dot2_f32_bf16 v23, v76, v16, 0
  v_dot2_f32_bf16 v23, v77, v17, v23
  v_dot2_f32_bf16 v23, v78, v18, v23
  v_dot2_f32_bf16 v23, v79, v19, v23
  s_waitcnt vmcnt(11)
  buffer_load_dwordx4 v[112:115], v1, s[24:27], s56 offen nt
  s_add_u32 s56, s56, 4096
  v_dot2_f32_bf16 v24, v80, v16, 0
  v_dot2_f32_bf16 v24, v81, v17, v24
  v_dot2_f32_bf16 v24, v82, v18, v24
  v_dot2_f32_bf16 v24, v83, v19, v24
  v_add_f32_dpp v22, v22, v22 row_ror:8 row_mask:0xf bank_mask:0x3
  s_nop 1
  v_add_f32_dpp v22, v23, v23 row_ror:8 row_mask:0xf bank_mask:0xc
  v_perm_b32 v38, v132, v128, s59
  v_perm_b32 v132, v132, v128, s60
  v_mov_b32 v128, v38
  v_perm_b32 v39, v133, v129, s59
  v_perm_b32 v133, v133, v129, s60
  v_mov_b32 v129, v39
  v_perm_b32 v38, v134, v130, s59
  v_perm_b32 v134, v134, v130, s60
  v_mov_b32 v130, v38
  v_perm_b32 v39, v135, v131, s59
  v_perm_b32 v135, v135, v131, s60
  v_mov_b32 v131, v39
  s_waitcnt vmcnt(11)
  buffer_load_dwordx4 v[116:119], v1, s[24:27], s56 offen nt
  s_add_u32 s56, s56, 4096
  buffer_load_dwordx4 v[152:155], v3, s[36:39], s58 offen nt
  s_add_u32 s58, s58, 4096
  v_dot2_f32_bf16 v25, v84, v16, 0
  v_dot2_f32_bf16 v25, v85, v17, v25
  v_dot2_f32_bf16 v25, v86, v18, v25
  v_dot2_f32_bf16 v25, v87, v19, v25
  v_add_f32_dpp v20, v20, v20 row_shl:4 row_mask:0xf bank_mask:0x5
  s_nop 1
  v_add_f32_dpp v20, v22, v22 row_shr:4 row_mask:0xf bank_mask:0xa
  s_waitcnt vmcnt(11)
  buffer_load_dwordx4 v[120:123], v1, s[24:27], s56 offen nt
  s_add_u32 s56, s56, 4096
  v_dot2_f32_bf16 v26, v88, v16, 0
  v_dot2_f32_bf16 v26, v89, v17, v26
  v_dot2_f32_bf16 v26, v90, v18, v26
  v_dot2_f32_bf16 v26, v91, v19, v26
  v_add_f32_dpp v24, v24, v24 row_ror:8 row_mask:0xf bank_mask:0x3
  s_nop 1
  v_add_f32_dpp v24, v25, v25 row_ror:8 row_mask:0xf bank_mask:0xc
  s_waitcnt vmcnt(11)
  buffer_load_dwordx4 v[124:127], v1, s[24:27], s56 offen nt
  s_add_u32 s56, s56, 4096
  buffer_load_dwordx4 v[156:159], v3, s[36:39], s58 offen nt
  s_add_u32 s58, s58, 4096
  v_dot2_f32_bf16 v27, v92, v16, 0
  v_dot2_f32_bf16 v27, v93, v17, v27
  v_dot2_f32_bf16 v27, v94, v18, v27
  v_dot2_f32_bf16 v27, v95, v19, v27
  s_waitcnt vmcnt(11)
  buffer_load_dwordx4 v[64:67], v1, s[24:27], s56 offen nt
  s_add_u32 s56, s56, 4096
  v_dot2_f32_bf16 v28, v96, v16, 0
  v_dot2_f32_bf16 v28, v97, v17, v28
  v_dot2_f32_bf16 v28, v98, v18, v28
  v_dot2_f32_bf16 v28, v99, v19, v28
  v_add_f32_dpp v26, v26, v26 row_ror:8 row_mask:0xf bank_mask:0x3
  s_nop 1
  v_add_f32_dpp v26, v27, v27 row_ror:8 row_mask:0xf bank_mask:0xc
  v_perm_b32 v38, v140, v136, s59
  v_perm_b32 v140, v140, v136, s60
  v_mov_b32 v136, v38
  v_perm_b32 v39, v141, v137, s59
  v_perm_b32 v141, v141, v137, s60
  v_mov_b32 v137, v39
  v_perm_b32 v38, v142, v138, s59
  v_perm_b32 v142, v142, v138, s60
  v_mov_b32 v138, v38
  v_perm_b32 v39, v143, v139, s59
  v_perm_b32 v143, v143, v139, s60
  v_mov_b32 v139, v39
  s_waitcnt vmcnt(11)
  buffer_load_dwordx4 v[68:71], v1, s[24:27], s56 offen nt
  s_add_u32 s56, s56, 4096
  buffer_load_dwordx4 v[160:163], v3, s[36:39], s58 offen nt
  s_add_u32 s58, s58, 4096
  v_dot2_f32_bf16 v29, v100, v16, 0
  v_dot2_f32_bf16 v29, v101, v17, v29
  v_dot2_f32_bf16 v29, v102, v18, v29
  v_dot2_f32_bf16 v29, v103, v19, v29
  v_add_f32_dpp v24, v24, v24 row_shl:4 row_mask:0xf bank_mask:0x5
  s_nop 1
  v_add_f32_dpp v24, v26, v26 row_shr:4 row_mask:0xf bank_mask:0xa
  s_waitcnt vmcnt(11)
  buffer_load_dwordx4 v[72:75], v1, s[24:27], s56 offen nt
  s_add_u32 s56, s56, 4096
  v_dot2_f32_bf16 v30, v104, v16, 0
  v_dot2_f32_bf16 v30, v105, v17, v30
  v_dot2_f32_bf16 v30, v106, v18, v30
  v_dot2_f32_bf16 v30, v107, v19, v30
  v_add_f32_dpp v28, v28, v28 row_ror:8 row_mask:0xf bank_mask:0x3
  s_nop 1
  v_add_f32_dpp v28, v29, v29 row_ror:8 row_mask:0xf bank_mask:0xc
  s_waitcnt vmcnt(11)
  buffer_load_dwordx4 v[76:79], v1, s[24:27], s56 offen nt
  s_add_u32 s56, s56, 4096
  buffer_load_dwordx4 v[164:167], v3, s[36:39], s58 offen nt
  s_add_u32 s58, s58, 4096
  v_dot2_f32_bf16 v31, v108, v16, 0
  v_dot2_f32_bf16 v31, v109, v17, v31
  v_dot2_f32_bf16 v31, v110, v18, v31
  v_dot2_f32_bf16 v31, v111, v19, v31
  s_waitcnt vmcnt(11)
  buffer_load_dwordx4 v[80:83], v1, s[24:27], s56 offen nt
  s_add_u32 s56, s56, 4096
  v_dot2_f32_bf16 v32, v112, v16, 0
  v_dot2_f32_bf16 v32, v113, v17, v32
  v_dot2_f32_bf16 v32, v114, v18, v32
  v_dot2_f32_bf16 v32, v115, v19, v32
  v_add_f32_dpp v30, v30, v30 row_ror:8 row_mask:0xf bank_mask:0x3
  s_nop 1
  v_add_f32_dpp v30, v31, v31 row_ror:8 row_mask:0xf bank_mask:0xc
  v_perm_b32 v38, v148, v144, s59
  v_perm_b32 v148, v148, v144, s60
  v_mov_b32 v144, v38
  v_perm_b32 v39, v149, v145, s59
  v_perm_b32 v149, v149, v145, s60
  v_mov_b32 v145, v39
  v_perm_b32 v38, v150, v146, s59
  v_perm_b32 v150, v150, v146, s60
  v_mov_b32 v146, v38
  v_perm_b32 v39, v151, v147, s59
  v_perm_b32 v151, v151, v147, s60
  v_mov_b32 v147, v39
  s_waitcnt vmcnt(11)
  buffer_load_dwordx4 v[84:87], v1, s[24:27], s56 offen nt
  s_add_u32 s56, s56, 4096
  buffer_load_dwordx4 v[168:171], v3, s[36:39], s58 offen nt
  s_add_u32 s58, s58, 4096
  v_dot2_f32_bf16 v33, v116, v16, 0
  v_dot2_f32_bf16 v33, v117, v17, v33
  v_dot2_f32_bf16 v33, v118, v18, v33
  v_dot2_f32_bf16 v33, v119, v19, v33
  v_add_f32_dpp v28, v28, v28 row_shl:4 row_mask:0xf bank_mask:0x5
  s_nop 1
  v_add_f32_dpp v28, v30, v30 row_shr:4 row_mask:0xf bank_mask:0xa
  s_waitcnt vmcnt(11)
  buffer_load_dwordx4 v[88:91], v1, s[24:27], s56 offen nt
  s_add_u32 s56, s56, 4096
  v_dot2_f32_bf16 v34, v120, v16, 0
  v_dot2_f32_bf16 v34, v121, v17, v34
  v_dot2_f32_bf16 v34, v122, v18, v34
  v_dot2_f32_bf16 v34, v123, v19, v34
  v_add_f32_dpp v32, v32, v32 row_ror:8 row_mask:0xf bank_mask:0x3
  s_nop 1
  v_add_f32_dpp v32, v33, v33 row_ror:8 row_mask:0xf bank_mask:0xc
  s_waitcnt vmcnt(11)
  buffer_load_dwordx4 v[92:95], v1, s[24:27], s56 offen nt
  s_add_u32 s56, s56, 4096
  buffer_load_dwordx4 v[172:175], v3, s[36:39], s58 offen nt
  s_add_u32 s58, s58, 4096
  v_dot2_f32_bf16 v35, v124, v16, 0
  v_dot2_f32_bf16 v35, v125, v17, v35
  v_dot2_f32_bf16 v35, v126, v18, v35
  v_dot2_f32_bf16 v35, v127, v19, v35
  v_add_f32_dpp v34, v34, v34 row_ror:8 row_mask:0xf bank_mask:0x3
  s_nop 1
  v_add_f32_dpp v34, v35, v35 row_ror:8 row_mask:0xf bank_mask:0xc
  v_add_f32_dpp v32, v32, v32 row_shl:4 row_mask:0xf bank_mask:0x5
  s_nop 1
  v_add_f32_dpp v32, v34, v34 row_shr:4 row_mask:0xf bank_mask:0xa
  v_add_f32_dpp v20, v20, v20 quad_perm:[1,0,3,2] row_mask:0xf bank_mask:0xf
  v_add_f32_dpp v24, v24, v24 quad_perm:[1,0,3,2] row_mask:0xf bank_mask:0xf
  v_add_f32_dpp v28, v28, v28 quad_perm:[1,0,3,2] row_mask:0xf bank_mask:0xf
  v_add_f32_dpp v32, v32, v32 quad_perm:[1,0,3,2] row_mask:0xf bank_mask:0xf
  v_add_f32_dpp v44, v20, v20 quad_perm:[2,3,0,1] row_mask:0xf bank_mask:0xf
  v_add_f32_dpp v45, v24, v24 quad_perm:[2,3,0,1] row_mask:0xf bank_mask:0xf
  v_add_f32_dpp v46, v28, v28 quad_perm:[2,3,0,1] row_mask:0xf bank_mask:0xf
  v_add_f32_dpp v47, v32, v32 quad_perm:[2,3,0,1] row_mask:0xf bank_mask:0xf
  v_mul_f32 v44, s61, v44
  v_mul_f32 v45, s61, v45
  v_mul_f32 v46, s61, v46
  v_mul_f32 v47, s61, v47
  ds_write_b128 v7, v[44:47] offset:4096
  v_max3_f32 v50, v48, v44, v45
  v_max3_f32 v50, v50, v46, v47
  v_sub_f32 v51, v48, v50
  v_sub_f32 v52, v44, v50
  v_sub_f32 v53, v45, v50
  v_sub_f32 v54, v46, v50
  v_sub_f32 v55, v47, v50
  v_exp_f32 v51, v51
  v_exp_f32 v52, v52
  v_exp_f32 v53, v53
  v_exp_f32 v54, v54
  v_exp_f32 v55, v55
  v_mov_b32 v48, v50
  v_add_f32 v52, v52, v53
  v_add_f32 v54, v54, v55
  v_add_f32 v52, v52, v54
  v_fma_f32 v49, v49, v51, v52
  s_waitcnt vmcnt(11)
  buffer_load_dwordx4 v[96:99], v1, s[24:27], s56 offen nt
  s_add_u32 s56, s56, 4096
  v_dot2_f32_bf16 v20, v64, v16, 0
  v_dot2_f32_bf16 v20, v65, v17, v20
  v_dot2_f32_bf16 v20, v66, v18, v20
  v_dot2_f32_bf16 v20, v67, v19, v20
  v_perm_b32 v38, v156, v152, s59
  v_perm_b32 v156, v156, v152, s60
  v_mov_b32 v152, v38
  v_perm_b32 v39, v157, v153, s59
  v_perm_b32 v157, v157, v153, s60
  v_mov_b32 v153, v39
  v_perm_b32 v38, v158, v154, s59
  v_perm_b32 v158, v158, v154, s60
  v_mov_b32 v154, v38
  v_perm_b32 v39, v159, v155, s59
  v_perm_b32 v159, v159, v155, s60
  v_mov_b32 v155, v39
  s_waitcnt vmcnt(11)
  buffer_load_dwordx4 v[100:103], v1, s[24:27], s56 offen nt
  s_add_u32 s56, s56, 4096
  buffer_load_dwordx4 v[176:179], v3, s[36:39], s58 offen nt
  s_add_u32 s58, s58, 4096
  v_dot2_f32_bf16 v21, v68, v16, 0
  v_dot2_f32_bf16 v21, v69, v17, v21
  v_dot2_f32_bf16 v21, v70, v18, v21
  v_dot2_f32_bf16 v21, v71, v19, v21
  s_waitcnt vmcnt(11)
  buffer_load_dwordx4 v[104:107], v1, s[24:27], s56 offen nt
  s_add_u32 s56, s56, 4096
  v_dot2_f32_bf16 v22, v72, v16, 0
  v_dot2_f32_bf16 v22, v73, v17, v22
  v_dot2_f32_bf16 v22, v74, v18, v22
  v_dot2_f32_bf16 v22, v75, v19, v22
  v_add_f32_dpp v20, v20, v20 row_ror:8 row_mask:0xf bank_mask:0x3
  s_nop 1
  v_add_f32_dpp v20, v21, v21 row_ror:8 row_mask:0xf bank_mask:0xc
  s_waitcnt vmcnt(11)
  buffer_load_dwordx4 v[108:111], v1, s[24:27], s56 offen nt
  s_add_u32 s56, s56, 4096
  buffer_load_dwordx4 v[180:183], v3, s[36:39], s58 offen nt
  s_add_u32 s58, s58, 4096
  v_dot2_f32_bf16 v23, v76, v16, 0
  v_dot2_f32_bf16 v23, v77, v17, v23
  v_dot2_f32_bf16 v23, v78, v18, v23
  v_dot2_f32_bf16 v23, v79, v19, v23
  s_waitcnt vmcnt(11)
  buffer_load_dwordx4 v[112:115], v1, s[24:27], s56 offen nt
  s_add_u32 s56, s56, 4096
  v_dot2_f32_bf16 v24, v80, v16, 0
  v_dot2_f32_bf16 v24, v81, v17, v24
  v_dot2_f32_bf16 v24, v82, v18, v24
  v_dot2_f32_bf16 v24, v83, v19, v24
  v_add_f32_dpp v22, v22, v22 row_ror:8 row_mask:0xf bank_mask:0x3
  s_nop 1
  v_add_f32_dpp v22, v23, v23 row_ror:8 row_mask:0xf bank_mask:0xc
  v_perm_b32 v38, v164, v160, s59
  v_perm_b32 v164, v164, v160, s60
  v_mov_b32 v160, v38
  v_perm_b32 v39, v165, v161, s59
  v_perm_b32 v165, v165, v161, s60
  v_mov_b32 v161, v39
  v_perm_b32 v38, v166, v162, s59
  v_perm_b32 v166, v166, v162, s60
  v_mov_b32 v162, v38
  v_perm_b32 v39, v167, v163, s59
  v_perm_b32 v167, v167, v163, s60
  v_mov_b32 v163, v39
  s_waitcnt vmcnt(11)
  buffer_load_dwordx4 v[116:119], v1, s[24:27], s56 offen nt
  s_add_u32 s56, s56, 4096
  buffer_load_dwordx4 v[184:187], v3, s[36:39], s58 offen nt
  s_add_u32 s58, s58, 4096
  v_dot2_f32_bf16 v25, v84, v16, 0
  v_dot2_f32_bf16 v25, v85, v17, v25
  v_dot2_f32_bf16 v25, v86, v18, v25
  v_dot2_f32_bf16 v25, v87, v19, v25
  v_add_f32_dpp v20, v20, v20 row_shl:4 row_mask:0xf bank_mask:0x5
  s_nop 1
  v_add_f32_dpp v20, v22, v22 row_shr:4 row_mask:0xf bank_mask:0xa
  s_waitcnt vmcnt(11)
  buffer_load_dwordx4 v[120:123], v1, s[24:27], s56 offen nt
  s_add_u32 s56, s56, 4096
  v_dot2_f32_bf16 v26, v88, v16, 0
  v_dot2_f32_bf16 v26, v89, v17, v26
  v_dot2_f32_bf16 v26, v90, v18, v26
  v_dot2_f32_bf16 v26, v91, v19, v26
  v_add_f32_dpp v24, v24, v24 row_ror:8 row_mask:0xf bank_mask:0x3
  s_nop 1
  v_add_f32_dpp v24, v25, v25 row_ror:8 row_mask:0xf bank_mask:0xc
  s_waitcnt vmcnt(11)
  buffer_load_dwordx4 v[124:127], v1, s[24:27], s56 offen nt
  s_add_u32 s56, s56, 4096
  buffer_load_dwordx4 v[188:191], v3, s[36:39], s58 offen nt
  s_add_u32 s58, s58, 4096
  v_dot2_f32_bf16 v27, v92, v16, 0
  v_dot2_f32_bf16 v27, v93, v17, v27
  v_dot2_f32_bf16 v27, v94, v18, v27
  v_dot2_f32_bf16 v27, v95, v19, v27
  s_waitcnt vmcnt(11)
  buffer_load_dwordx4 v[64:67], v1, s[24:27], s56 offen nt
  s_add_u32 s56, s56, 4096
  v_dot2_f32_bf16 v28, v96, v16, 0
  v_dot2_f32_bf16 v28, v97, v17, v28
  v_dot2_f32_bf16 v28, v98, v18, v28
  v_dot2_f32_bf16 v28, v99, v19, v28
  v_add_f32_dpp v26, v26, v26 row_ror:8 row_mask:0xf bank_mask:0x3
  s_nop 1
  v_add_f32_dpp v26, v27, v27 row_ror:8 row_mask:0xf bank_mask:0xc
  v_perm_b32 v38, v172, v168, s59
  v_perm_b32 v172, v172, v168, s60
  v_mov_b32 v168, v38
  v_perm_b32 v39, v173, v169, s59
  v_perm_b32 v173, v173, v169, s60
  v_mov_b32 v169, v39
  v_perm_b32 v38, v174, v170, s59
  v_perm_b32 v174, v174, v170, s60
  v_mov_b32 v170, v38
  v_perm_b32 v39, v175, v171, s59
  v_perm_b32 v175, v175, v171, s60
  v_mov_b32 v171, v39
  s_waitcnt vmcnt(11)
  buffer_load_dwordx4 v[68:71], v1, s[24:27], s56 offen nt
  s_add_u32 s56, s56, 4096
  buffer_load_dwordx4 v[192:195], v3, s[36:39], s58 offen nt
  s_add_u32 s58, s58, 4096
  v_dot2_f32_bf16 v29, v100, v16, 0
  v_dot2_f32_bf16 v29, v101, v17, v29
  v_dot2_f32_bf16 v29, v102, v18, v29
  v_dot2_f32_bf16 v29, v103, v19, v29
  v_add_f32_dpp v24, v24, v24 row_shl:4 row_mask:0xf bank_mask:0x5
  s_nop 1
  v_add_f32_dpp v24, v26, v26 row_shr:4 row_mask:0xf bank_mask:0xa
  s_waitcnt vmcnt(11)
  buffer_load_dwordx4 v[72:75], v1, s[24:27], s56 offen nt
  s_add_u32 s56, s56, 4096
  v_dot2_f32_bf16 v30, v104, v16, 0
  v_dot2_f32_bf16 v30, v105, v17, v30
  v_dot2_f32_bf16 v30, v106, v18, v30
  v_dot2_f32_bf16 v30, v107, v19, v30
  v_add_f32_dpp v28, v28, v28 row_ror:8 row_mask:0xf bank_mask:0x3
  s_nop 1
  v_add_f32_dpp v28, v29, v29 row_ror:8 row_mask:0xf bank_mask:0xc
  s_waitcnt vmcnt(11)
  buffer_load_dwordx4 v[76:79], v1, s[24:27], s56 offen nt
  s_add_u32 s56, s56, 4096
  buffer_load_dwordx4 v[196:199], v3, s[36:39], s58 offen nt
  s_add_u32 s58, s58, 4096
  v_dot2_f32_bf16 v31, v108, v16, 0
  v_dot2_f32_bf16 v31, v109, v17, v31
  v_dot2_f32_bf16 v31, v110, v18, v31
  v_dot2_f32_bf16 v31, v111, v19, v31
  s_waitcnt vmcnt(11)
  buffer_load_dwordx4 v[80:83], v1, s[24:27], s56 offen nt
  s_add_u32 s56, s56, 4096
  v_dot2_f32_bf16 v32, v112, v16, 0
  v_dot2_f32_bf16 v32, v113, v17, v32
  v_dot2_f32_bf16 v32, v114, v18, v32
  v_dot2_f32_bf16 v32, v115, v19, v32
  v_add_f32_dpp v30, v30, v30 row_ror:8 row_mask:0xf bank_mask:0x3
  s_nop 1
  v_add_f32_dpp v30, v31, v31 row_ror:8 row_mask:0xf bank_mask:0xc
  v_perm_b32 v38, v180, v176, s59
  v_perm_b32 v180, v180, v176, s60
  v_mov_b32 v176, v38
  v_perm_b32 v39, v181, v177, s59
  v_perm_b32 v181, v181, v177, s60
  v_mov_b32 v177, v39
  v_perm_b32 v38, v182, v178, s59
  v_perm_b32 v182, v182, v178, s60
  v_mov_b32 v178, v38
  v_perm_b32 v39, v183, v179, s59
  v_perm_b32 v183, v183, v179, s60
  v_mov_b32 v179, v39
  s_waitcnt vmcnt(11)
  buffer_load_dwordx4 v[84:87], v1, s[24:27], s56 offen nt
  s_add_u32 s56, s56, 4096
  buffer_load_dwordx4 v[200:203], v3, s[36:39], s58 offen nt
  s_add_u32 s58, s58, 4096
  v_dot2_f32_bf16 v33, v116, v16, 0
  v_dot2_f32_bf16 v33, v117, v17, v33
  v_dot2_f32_bf16 v33, v118, v18, v33
  v_dot2_f32_bf16 v33, v119, v19, v33
  v_add_f32_dpp v28, v28, v28 row_shl:4 row_mask:0xf bank_mask:0x5
  s_nop 1
  v_add_f32_dpp v28, v30, v30 row_shr:4 row_mask:0xf bank_mask:0xa
  s_waitcnt vmcnt(11)
  buffer_load_dwordx4 v[88:91], v1, s[24:27], s56 offen nt
  s_add_u32 s56, s56, 4096
  v_dot2_f32_bf16 v34, v120, v16, 0
  v_dot2_f32_bf16 v34, v121, v17, v34
  v_dot2_f32_bf16 v34, v122, v18, v34
  v_dot2_f32_bf16 v34, v123, v19, v34
  v_add_f32_dpp v32, v32, v32 row_ror:8 row_mask:0xf bank_mask:0x3
  s_nop 1
  v_add_f32_dpp v32, v33, v33 row_ror:8 row_mask:0xf bank_mask:0xc
  s_waitcnt vmcnt(11)
  buffer_load_dwordx4 v[92:95], v1, s[24:27], s56 offen nt
  s_add_u32 s56, s56, 4096
  buffer_load_dwordx4 v[204:207], v3, s[36:39], s58 offen nt
  s_add_u32 s58, s58, 4096
  v_dot2_f32_bf16 v35, v124, v16, 0
  v_dot2_f32_bf16 v35, v125, v17, v35
  v_dot2_f32_bf16 v35, v126, v18, v35
  v_dot2_f32_bf16 v35, v127, v19, v35
  v_add_f32_dpp v34, v34, v34 row_ror:8 row_mask:0xf bank_mask:0x3
  s_nop 1
  v_add_f32_dpp v34, v35, v35 row_ror:8 row_mask:0xf bank_mask:0xc
  v_add_f32_dpp v32, v32, v32 row_shl:4 row_mask:0xf bank_mask:0x5
  s_nop 1
  v_add_f32_dpp v32, v34, v34 row_shr:4 row_mask:0xf bank_mask:0xa
  v_add_f32_dpp v20, v20, v20 quad_perm:[1,0,3,2] row_mask:0xf bank_mask:0xf
  v_add_f32_dpp v24, v24, v24 quad_perm:[1,0,3,2] row_mask:0xf bank_mask:0xf
  v_add_f32_dpp v28, v28, v28 quad_perm:[1,0,3,2] row_mask:0xf bank_mask:0xf
  v_add_f32_dpp v32, v32, v32 quad_perm:[1,0,3,2] row_mask:0xf bank_mask:0xf
  v_add_f32_dpp v44, v20, v20 quad_perm:[2,3,0,1] row_mask:0xf bank_mask:0xf
  v_add_f32_dpp v45, v24, v24 quad_perm:[2,3,0,1] row_mask:0xf bank_mask:0xf
  v_add_f32_dpp v46, v28, v28 quad_perm:[2,3,0,1] row_mask:0xf bank_mask:0xf
  v_add_f32_dpp v47, v32, v32 quad_perm:[2,3,0,1] row_mask:0xf bank_mask:0xf
  v_mul_f32 v44, s61, v44
  v_mul_f32 v45, s61, v45
  v_mul_f32 v46, s61, v46
  v_mul_f32 v47, s61, v47
  ds_write_b128 v7, v[44:47] offset:5120
  v_max3_f32 v50, v48, v44, v45
  v_max3_f32 v50, v50, v46, v47
  v_sub_f32 v51, v48, v50
  v_sub_f32 v52, v44, v50
  v_sub_f32 v53, v45, v50
  v_sub_f32 v54, v46, v50
  v_sub_f32 v55, v47, v50
  v_exp_f32 v51, v51
  v_exp_f32 v52, v52
  v_exp_f32 v53, v53
  v_exp_f32 v54, v54
  v_exp_f32 v55, v55
  v_mov_b32 v48, v50
  v_add_f32 v52, v52, v53
  v_add_f32 v54, v54, v55
  v_add_f32 v52, v52, v54
  v_fma_f32 v49, v49, v51, v52
  s_waitcnt vmcnt(11)
  buffer_load_dwordx4 v[96:99], v1, s[24:27], s56 offen nt
  s_add_u32 s56, s56, 4096
  v_dot2_f32_bf16 v20, v64, v16, 0
  v_dot2_f32_bf16 v20, v65, v17, v20
  v_dot2_f32_bf16 v20, v66, v18, v20
  v_dot2_f32_bf16 v20, v67, v19, v20
  v_perm_b32 v38, v188, v184, s59
  v_perm_b32 v188, v188, v184, s60
  v_mov_b32 v184, v38
  v_perm_b32 v39, v189, v185, s59
  v_perm_b32 v189, v189, v185, s60
  v_mov_b32 v185, v39
  v_perm_b32 v38, v190, v186, s59
  v_perm_b32 v190, v190, v186, s60
  v_mov_b32 v186, v38
  v_perm_b32 v39, v191, v187, s59
  v_perm_b32 v191, v191, v187, s60
  v_mov_b32 v187, v39
  s_waitcnt vmcnt(11)
  buffer_load_dwordx4 v[100:103], v1, s[24:27], s56 offen nt
  s_add_u32 s56, s56, 4096
  buffer_load_dwordx4 v[208:211], v3, s[36:39], s58 offen nt
  s_add_u32 s58, s58, 4096
  v_dot2_f32_bf16 v21, v68, v16, 0
  v_dot2_f32_bf16 v21, v69, v17, v21
  v_dot2_f32_bf16 v21, v70, v18, v21
  v_dot2_f32_bf16 v21, v71, v19, v21
  s_waitcnt vmcnt(11)
  buffer_load_dwordx4 v[104:107], v1, s[24:27], s56 offen nt
  s_add_u32 s56, s56, 4096
  v_dot2_f32_bf16 v22, v72, v16, 0
  v_dot2_f32_bf16 v22, v73, v17, v22
  v_dot2_f32_bf16 v22, v74, v18, v22
  v_dot2_f32_bf16 v22, v75, v19, v22
  v_add_f32_dpp v20, v20, v20 row_ror:8 row_mask:0xf bank_mask:0x3
  s_nop 1
  v_add_f32_dpp v20, v21, v21 row_ror:8 row_mask:0xf bank_mask:0xc
  s_waitcnt vmcnt(11)
  buffer_load_dwordx4 v[108:111], v1, s[24:27], s56 offen nt
  s_add_u32 s56, s56, 4096
  buffer_load_dwordx4 v[212:215], v3, s[36:39], s58 offen nt
  s_add_u32 s58, s58, 4096
  v_dot2_f32_bf16 v23, v76, v16, 0
  v_dot2_f32_bf16 v23, v77, v17, v23
  v_dot2_f32_bf16 v23, v78, v18, v23
  v_dot2_f32_bf16 v23, v79, v19, v23
  s_waitcnt vmcnt(11)
  buffer_load_dwordx4 v[112:115], v1, s[24:27], s56 offen nt
  s_add_u32 s56, s56, 4096
  v_dot2_f32_bf16 v24, v80, v16, 0
  v_dot2_f32_bf16 v24, v81, v17, v24
  v_dot2_f32_bf16 v24, v82, v18, v24
  v_dot2_f32_bf16 v24, v83, v19, v24
  v_add_f32_dpp v22, v22, v22 row_ror:8 row_mask:0xf bank_mask:0x3
  s_nop 1
  v_add_f32_dpp v22, v23, v23 row_ror:8 row_mask:0xf bank_mask:0xc
  v_perm_b32 v38, v196, v192, s59
  v_perm_b32 v196, v196, v192, s60
  v_mov_b32 v192, v38
  v_perm_b32 v39, v197, v193, s59
  v_perm_b32 v197, v197, v193, s60
  v_mov_b32 v193, v39
  v_perm_b32 v38, v198, v194, s59
  v_perm_b32 v198, v198, v194, s60
  v_mov_b32 v194, v38
  v_perm_b32 v39, v199, v195, s59
  v_perm_b32 v199, v199, v195, s60
  v_mov_b32 v195, v39
  s_waitcnt vmcnt(11)
  buffer_load_dwordx4 v[116:119], v1, s[24:27], s56 offen nt
  s_add_u32 s56, s56, 4096
  buffer_load_dwordx4 v[216:219], v3, s[36:39], s58 offen nt
  s_add_u32 s58, s58, 4096
  v_dot2_f32_bf16 v25, v84, v16, 0
  v_dot2_f32_bf16 v25, v85, v17, v25
  v_dot2_f32_bf16 v25, v86, v18, v25
  v_dot2_f32_bf16 v25, v87, v19, v25
  v_add_f32_dpp v20, v20, v20 row_shl:4 row_mask:0xf bank_mask:0x5
  s_nop 1
  v_add_f32_dpp v20, v22, v22 row_shr:4 row_mask:0xf bank_mask:0xa
  s_waitcnt vmcnt(11)
  buffer_load_dwordx4 v[120:123], v1, s[24:27], s56 offen nt
  s_add_u32 s56, s56, 4096
  v_dot2_f32_bf16 v26, v88, v16, 0
  v_dot2_f32_bf16 v26, v89, v17, v26
  v_dot2_f32_bf16 v26, v90, v18, v26
  v_dot2_f32_bf16 v26, v91, v19, v26
  v_add_f32_dpp v24, v24, v24 row_ror:8 row_mask:0xf bank_mask:0x3
  s_nop 1
  v_add_f32_dpp v24, v25, v25 row_ror:8 row_mask:0xf bank_mask:0xc
  s_waitcnt vmcnt(11)
  buffer_load_dwordx4 v[124:127], v1, s[24:27], s56 offen nt
  s_add_u32 s56, s56, 4096
  buffer_load_dwordx4 v[220:223], v3, s[36:39], s58 offen nt
  s_add_u32 s58, s58, 4096
  v_dot2_f32_bf16 v27, v92, v16, 0
  v_dot2_f32_bf16 v27, v93, v17, v27
  v_dot2_f32_bf16 v27, v94, v18, v27
  v_dot2_f32_bf16 v27, v95, v19, v27
  s_waitcnt vmcnt(11)
  buffer_load_dwordx4 v[64:67], v1, s[24:27], s56 offen nt
  s_add_u32 s56, s56, 4096
  v_dot2_f32_bf16 v28, v96, v16, 0
  v_dot2_f32_bf16 v28, v97, v17, v28
  v_dot2_f32_bf16 v28, v98, v18, v28
  v_dot2_f32_bf16 v28, v99, v19, v28
  v_add_f32_dpp v26, v26, v26 row_ror:8 row_mask:0xf bank_mask:0x3
  s_nop 1
  v_add_f32_dpp v26, v27, v27 row_ror:8 row_mask:0xf bank_mask:0xc
  v_perm_b32 v38, v204, v200, s59
  v_perm_b32 v204, v204, v200, s60
  v_mov_b32 v200, v38
  v_perm_b32 v39, v205, v201, s59
  v_perm_b32 v205, v205, v201, s60
  v_mov_b32 v201, v39
  v_perm_b32 v38, v206, v202, s59
  v_perm_b32 v206, v206, v202, s60
  v_mov_b32 v202, v38
  v_perm_b32 v39, v207, v203, s59
  v_perm_b32 v207, v207, v203, s60
  v_mov_b32 v203, v39
  s_waitcnt vmcnt(11)
  buffer_load_dwordx4 v[68:71], v1, s[24:27], s56 offen nt
  s_add_u32 s56, s56, 4096
  buffer_load_dwordx4 v[224:227], v3, s[36:39], s58 offen nt
  s_add_u32 s58, s58, 4096
  v_dot2_f32_bf16 v29, v100, v16, 0
  v_dot2_f32_bf16 v29, v101, v17, v29
  v_dot2_f32_bf16 v29, v102, v18, v29
  v_dot2_f32_bf16 v29, v103, v19, v29
  v_add_f32_dpp v24, v24, v24 row_shl:4 row_mask:0xf bank_mask:0x5
  s_nop 1
  v_add_f32_dpp v24, v26, v26 row_shr:4 row_mask:0xf bank_mask:0xa
  s_waitcnt vmcnt(11)
  buffer_load_dwordx4 v[72:75], v1, s[24:27], s56 offen nt
  s_add_u32 s56, s56, 4096
  v_dot2_f32_bf16 v30, v104, v16, 0
  v_dot2_f32_bf16 v30, v105, v17, v30
  v_dot2_f32_bf16 v30, v106, v18, v30
  v_dot2_f32_bf16 v30, v107, v19, v30
  v_add_f32_dpp v28, v28, v28 row_ror:8 row_mask:0xf bank_mask:0x3
  s_nop 1
  v_add_f32_dpp v28, v29, v29 row_ror:8 row_mask:0xf bank_mask:0xc
  s_waitcnt vmcnt(11)
  buffer_load_dwordx4 v[76:79], v1, s[24:27], s56 offen nt
  s_add_u32 s56, s56, 4096
  buffer_load_dwordx4 v[228:231], v3, s[36:39], s58 offen nt
  s_add_u32 s58, s58, 4096
  v_dot2_f32_bf16 v31, v108, v16, 0
  v_dot2_f32_bf16 v31, v109, v17, v31
  v_dot2_f32_bf16 v31, v110, v18, v31
  v_dot2_f32_bf16 v31, v111, v19, v31
  s_waitcnt vmcnt(11)
  buffer_load_dwordx4 v[80:83], v1, s[24:27], s56 offen nt
  s_add_u32 s56, s56, 4096
  v_dot2_f32_bf16 v32, v112, v16, 0
  v_dot2_f32_bf16 v32, v113, v17, v32
  v_dot2_f32_bf16 v32, v114, v18, v32
  v_dot2_f32_bf16 v32, v115, v19, v32
  v_add_f32_dpp v30, v30, v30 row_ror:8 row_mask:0xf bank_mask:0x3
  s_nop 1
  v_add_f32_dpp v30, v31, v31 row_ror:8 row_mask:0xf bank_mask:0xc
  v_perm_b32 v38, v212, v208, s59
  v_perm_b32 v212, v212, v208, s60
  v_mov_b32 v208, v38
  v_perm_b32 v39, v213, v209, s59
  v_perm_b32 v213, v213, v209, s60
  v_mov_b32 v209, v39
  v_perm_b32 v38, v214, v210, s59
  v_perm_b32 v214, v214, v210, s60
  v_mov_b32 v210, v38
  v_perm_b32 v39, v215, v211, s59
  v_perm_b32 v215, v215, v211, s60
  v_mov_b32 v211, v39
  s_waitcnt vmcnt(11)
  buffer_load_dwordx4 v[84:87], v1, s[24:27], s56 offen nt
  s_add_u32 s56, s56, 4096
  buffer_load_dwordx4 v[232:235], v3, s[36:39], s58 offen nt
  s_add_u32 s58, s58, 4096
  v_dot2_f32_bf16 v33, v116, v16, 0
  v_dot2_f32_bf16 v33, v117, v17, v33
  v_dot2_f32_bf16 v33, v118, v18, v33
  v_dot2_f32_bf16 v33, v119, v19, v33
  v_add_f32_dpp v28, v28, v28 row_shl:4 row_mask:0xf bank_mask:0x5
  s_nop 1
  v_add_f32_dpp v28, v30, v30 row_shr:4 row_mask:0xf bank_mask:0xa
  s_waitcnt vmcnt(11)
  buffer_load_dwordx4 v[88:91], v1, s[24:27], s56 offen nt
  s_add_u32 s56, s56, 4096
  v_dot2_f32_bf16 v34, v120, v16, 0
  v_dot2_f32_bf16 v34, v121, v17, v34
  v_dot2_f32_bf16 v34, v122, v18, v34
  v_dot2_f32_bf16 v34, v123, v19, v34
  v_add_f32_dpp v32, v32, v32 row_ror:8 row_mask:0xf bank_mask:0x3
  s_nop 1
  v_add_f32_dpp v32, v33, v33 row_ror:8 row_mask:0xf bank_mask:0xc
  s_waitcnt vmcnt(11)
  buffer_load_dwordx4 v[92:95], v1, s[24:27], s56 offen nt
  s_add_u32 s56, s56, 4096
  buffer_load_dwordx4 v[236:239], v3, s[36:39], s58 offen nt
  s_add_u32 s58, s58, 4096
  v_dot2_f32_bf16 v35, v124, v16, 0
  v_dot2_f32_bf16 v35, v125, v17, v35
  v_dot2_f32_bf16 v35, v126, v18, v35
  v_dot2_f32_bf16 v35, v127, v19, v35
  v_add_f32_dpp v34, v34, v34 row_ror:8 row_mask:0xf bank_mask:0x3
  s_nop 1
  v_add_f32_dpp v34, v35, v35 row_ror:8 row_mask:0xf bank_mask:0xc
  v_add_f32_dpp v32, v32, v32 row_shl:4 row_mask:0xf bank_mask:0x5
  s_nop 1
  v_add_f32_dpp v32, v34, v34 row_shr:4 row_mask:0xf bank_mask:0xa
  v_add_f32_dpp v20, v20, v20 quad_perm:[1,0,3,2] row_mask:0xf bank_mask:0xf
  v_add_f32_dpp v24, v24, v24 quad_perm:[1,0,3,2] row_mask:0xf bank_mask:0xf
  v_add_f32_dpp v28, v28, v28 quad_perm:[1,0,3,2] row_mask:0xf bank_mask:0xf
  v_add_f32_dpp v32, v32, v32 quad_perm:[1,0,3,2] row_mask:0xf bank_mask:0xf
  v_add_f32_dpp v44, v20, v20 quad_perm:[2,3,0,1] row_mask:0xf bank_mask:0xf
  v_add_f32_dpp v45, v24, v24 quad_perm:[2,3,0,1] row_mask:0xf bank_mask:0xf
  v_add_f32_dpp v46, v28, v28 quad_perm:[2,3,0,1] row_mask:0xf bank_mask:0xf
  v_add_f32_dpp v47, v32, v32 quad_perm:[2,3,0,1] row_mask:0xf bank_mask:0xf
  v_mul_f32 v44, s61, v44
  v_mul_f32 v45, s61, v45
  v_mul_f32 v46, s61, v46
  v_mul_f32 v47, s61, v47
  ds_write_b128 v7, v[44:47] offset:6144
  v_max3_f32 v50, v48, v44, v45
  v_max3_f32 v50, v50, v46, v47
  v_sub_f32 v51, v48, v50
  v_sub_f32 v52, v44, v50
  v_sub_f32 v53, v45, v50
  v_sub_f32 v54, v46, v50
  v_sub_f32 v55, v47, v50
  v_exp_f32 v51, v51
  v_exp_f32 v52, v52
  v_exp_f32 v53, v53
  v_exp_f32 v54, v54
  v_exp_f32 v55, v55
  v_mov_b32 v48, v50
  v_add_f32 v52, v52, v53
  v_add_f32 v54, v54, v55
  v_add_f32 v52, v52, v54
  v_fma_f32 v49, v49, v51, v52
  s_waitcnt vmcnt(11)
  buffer_load_dwordx4 v[96:99], v1, s[24:27], s56 offen nt
  s_add_u32 s56, s56, 4096
  v_dot2_f32_bf16 v20, v64, v16, 0
  v_dot2_f32_bf16 v20, v65, v17, v20
  v_dot2_f32_bf16 v20, v66, v18, v20
  v_dot2_f32_bf16 v20, v67, v19, v20
  v_perm_b32 v38, v220, v216, s59
  v_perm_b32 v220, v220, v216, s60
  v_mov_b32 v216, v38
  v_perm_b32 v39, v221, v217, s59
  v_perm_b32 v221, v221, v217, s60
  v_mov_b32 v217, v39
  v_perm_b32 v38, v222, v218, s59
  v_perm_b32 v222, v222, v218, s60
  v_mov_b32 v218, v38
  v_perm_b32 v39, v223, v219, s59
  v_perm_b32 v223, v223, v219, s60
  v_mov_b32 v219, v39
  s_waitcnt vmcnt(11)
  buffer_load_dwordx4 v[100:103], v1, s[24:27], s56 offen nt
  s_add_u32 s56, s56, 4096
  buffer_load_dwordx4 v[240:243], v3, s[36:39], s58 offen nt
  s_add_u32 s58, s58, 4096
  v_dot2_f32_bf16 v21, v68, v16, 0
  v_dot2_f32_bf16 v21, v69, v17, v21
  v_dot2_f32_bf16 v21, v70, v18, v21
  v_dot2_f32_bf16 v21, v71, v19, v21
  s_waitcnt vmcnt(11)
  buffer_load_dwordx4 v[104:107], v1, s[24:27], s56 offen nt
  s_add_u32 s56, s56, 4096
  v_dot2_f32_bf16 v22, v72, v16, 0
  v_dot2_f32_bf16 v22, v73, v17, v22
  v_dot2_f32_bf16 v22, v74, v18, v22
  v_dot2_f32_bf16 v22, v75, v19, v22
  v_add_f32_dpp v20, v20, v20 row_ror:8 row_mask:0xf bank_mask:0x3
  s_nop 1
  v_add_f32_dpp v20, v21, v21 row_ror:8 row_mask:0xf bank_mask:0xc
  s_waitcnt vmcnt(11)
  buffer_load_dwordx4 v[108:111], v1, s[24:27], s56 offen nt
  s_add_u32 s56, s56, 4096
  buffer_load_dwordx4 v[244:247], v3, s[36:39], s58 offen nt
  s_add_u32 s58, s58, 4096
  v_dot2_f32_bf16 v23, v76, v16, 0
  v_dot2_f32_bf16 v23, v77, v17, v23
  v_dot2_f32_bf16 v23, v78, v18, v23
  v_dot2_f32_bf16 v23, v79, v19, v23
  s_waitcnt vmcnt(11)
  buffer_load_dwordx4 v[112:115], v1, s[24:27], s56 offen nt
  s_add_u32 s56, s56, 4096
  v_dot2_f32_bf16 v24, v80, v16, 0
  v_dot2_f32_bf16 v24, v81, v17, v24
  v_dot2_f32_bf16 v24, v82, v18, v24
  v_dot2_f32_bf16 v24, v83, v19, v24
  v_add_f32_dpp v22, v22, v22 row_ror:8 row_mask:0xf bank_mask:0x3
  s_nop 1
  v_add_f32_dpp v22, v23, v23 row_ror:8 row_mask:0xf bank_mask:0xc
  v_perm_b32 v38, v228, v224, s59
  v_perm_b32 v228, v228, v224, s60
  v_mov_b32 v224, v38
  v_perm_b32 v39, v229, v225, s59
  v_perm_b32 v229, v229, v225, s60
  v_mov_b32 v225, v39
  v_perm_b32 v38, v230, v226, s59
  v_perm_b32 v230, v230, v226, s60
  v_mov_b32 v226, v38
  v_perm_b32 v39, v231, v227, s59
  v_perm_b32 v231, v231, v227, s60
  v_mov_b32 v227, v39
  s_waitcnt vmcnt(11)
  buffer_load_dwordx4 v[116:119], v1, s[24:27], s56 offen nt
  s_add_u32 s56, s56, 4096
  buffer_load_dwordx4 v[248:251], v3, s[36:39], s58 offen nt
  s_add_u32 s58, s58, 4096
  v_dot2_f32_bf16 v25, v84, v16, 0
  v_dot2_f32_bf16 v25, v85, v17, v25
  v_dot2_f32_bf16 v25, v86, v18, v25
  v_dot2_f32_bf16 v25, v87, v19, v25
  v_add_f32_dpp v20, v20, v20 row_shl:4 row_mask:0xf bank_mask:0x5
  s_nop 1
  v_add_f32_dpp v20, v22, v22 row_shr:4 row_mask:0xf bank_mask:0xa
  s_waitcnt vmcnt(11)
  buffer_load_dwordx4 v[120:123], v1, s[24:27], s56 offen nt
  s_add_u32 s56, s56, 4096
  v_dot2_f32_bf16 v26, v88, v16, 0
  v_dot2_f32_bf16 v26, v89, v17, v26
  v_dot2_f32_bf16 v26, v90, v18, v26
  v_dot2_f32_bf16 v26, v91, v19, v26
  v_add_f32_dpp v24, v24, v24 row_ror:8 row_mask:0xf bank_mask:0x3
  s_nop 1
  v_add_f32_dpp v24, v25, v25 row_ror:8 row_mask:0xf bank_mask:0xc
  s_waitcnt vmcnt(11)
  buffer_load_dwordx4 v[124:127], v1, s[24:27], s56 offen nt
  s_add_u32 s56, s56, 4096
  s_mov_b32 s56, 0
  buffer_load_dwordx4 v[252:255], v3, s[36:39], s58 offen nt
  s_add_u32 s58, s58, 4096
  v_dot2_f32_bf16 v27, v92, v16, 0
  v_dot2_f32_bf16 v27, v93, v17, v27
  v_dot2_f32_bf16 v27, v94, v18, v27
  v_dot2_f32_bf16 v27, v95, v19, v27
  s_waitcnt vmcnt(11)
  buffer_load_dwordx4 v[64:67], v1, s[28:31], s56 offen nt
  s_add_u32 s56, s56, 4096
  v_dot2_f32_bf16 v28, v96, v16, 0
  v_dot2_f32_bf16 v28, v97, v17, v28
  v_dot2_f32_bf16 v28, v98, v18, v28
  v_dot2_f32_bf16 v28, v99, v19, v28
  v_add_f32_dpp v26, v26, v26 row_ror:8 row_mask:0xf bank_mask:0x3
  s_nop 1
  v_add_f32_dpp v26, v27, v27 row_ror:8 row_mask:0xf bank_mask:0xc
  v_perm_b32 v38, v236, v232, s59
  v_perm_b32 v236, v236, v232, s60
  v_mov_b32 v232, v38
  v_perm_b32 v39, v237, v233, s59
  v_perm_b32 v237, v237, v233, s60
  v_mov_b32 v233, v39
  v_perm_b32 v38, v238, v234, s59
  v_perm_b32 v238, v238, v234, s60
  v_mov_b32 v234, v38
  v_perm_b32 v39, v239, v235, s59
  v_perm_b32 v239, v239, v235, s60
  v_mov_b32 v235, v39
  s_waitcnt vmcnt(11)
  buffer_load_dwordx4 v[68:71], v1, s[28:31], s56 offen nt
  s_add_u32 s56, s56, 4096
  v_dot2_f32_bf16 v29, v100, v16, 0
  v_dot2_f32_bf16 v29, v101, v17, v29
  v_dot2_f32_bf16 v29, v102, v18, v29
  v_dot2_f32_bf16 v29, v103, v19, v29
  v_add_f32_dpp v24, v24, v24 row_shl:4 row_mask:0xf bank_mask:0x5
  s_nop 1
  v_add_f32_dpp v24, v26, v26 row_shr:4 row_mask:0xf bank_mask:0xa
  s_waitcnt vmcnt(10)
  buffer_load_dwordx4 v[72:75], v1, s[28:31], s56 offen nt
  s_add_u32 s56, s56, 4096
  v_dot2_f32_bf16 v30, v104, v16, 0
  v_dot2_f32_bf16 v30, v105, v17, v30
  v_dot2_f32_bf16 v30, v106, v18, v30
  v_dot2_f32_bf16 v30, v107, v19, v30
  v_add_f32_dpp v28, v28, v28 row_ror:8 row_mask:0xf bank_mask:0x3
  s_nop 1
  v_add_f32_dpp v28, v29, v29 row_ror:8 row_mask:0xf bank_mask:0xc
  s_waitcnt vmcnt(10)
  buffer_load_dwordx4 v[76:79], v1, s[28:31], s56 offen nt
  s_add_u32 s56, s56, 4096
  v_dot2_f32_bf16 v31, v108, v16, 0
  v_dot2_f32_bf16 v31, v109, v17, v31
  v_dot2_f32_bf16 v31, v110, v18, v31
  v_dot2_f32_bf16 v31, v111, v19, v31
  s_waitcnt vmcnt(9)
  buffer_load_dwordx4 v[80:83], v1, s[28:31], s56 offen nt
  s_add_u32 s56, s56, 4096
  v_dot2_f32_bf16 v32, v112, v16, 0
  v_dot2_f32_bf16 v32, v113, v17, v32
  v_dot2_f32_bf16 v32, v114, v18, v32
  v_dot2_f32_bf16 v32, v115, v19, v32
  v_add_f32_dpp v30, v30, v30 row_ror:8 row_mask:0xf bank_mask:0x3
  s_nop 1
  v_add_f32_dpp v30, v31, v31 row_ror:8 row_mask:0xf bank_mask:0xc
  v_perm_b32 v38, v244, v240, s59
  v_perm_b32 v244, v244, v240, s60
  v_mov_b32 v240, v38
  v_perm_b32 v39, v245, v241, s59
  v_perm_b32 v245, v245, v241, s60
  v_mov_b32 v241, v39
  v_perm_b32 v38, v246, v242, s59
  v_perm_b32 v246, v246, v242, s60
  v_mov_b32 v242, v38
  v_perm_b32 v39, v247, v243, s59
  v_perm_b32 v247, v247, v243, s60
  v_mov_b32 v243, v39
  s_waitcnt vmcnt(9)
  buffer_load_dwordx4 v[84:87], v1, s[28:31], s56 offen nt
  s_add_u32 s56, s56, 4096
  v_dot2_f32_bf16 v33, v116, v16, 0
  v_dot2_f32_bf16 v33, v117, v17, v33
  v_dot2_f32_bf16 v33, v118, v18, v33
  v_dot2_f32_bf16 v33, v119, v19, v33
  v_add_f32_dpp v28, v28, v28 row_shl:4 row_mask:0xf bank_mask:0x5
  s_nop 1
  v_add_f32_dpp v28, v30, v30 row_shr:4 row_mask:0xf bank_mask:0xa
  s_waitcnt vmcnt(8)
  buffer_load_dwordx4 v[88:91], v1, s[28:31], s56 offen nt
  s_add_u32 s56, s56, 4096
  v_dot2_f32_bf16 v34, v120, v16, 0
  v_dot2_f32_bf16 v34, v121, v17, v34
  v_dot2_f32_bf16 v34, v122, v18, v34
  v_dot2_f32_bf16 v34, v123, v19, v34
  v_add_f32_dpp v32, v32, v32 row_ror:8 row_mask:0xf bank_mask:0x3
  s_nop 1
  v_add_f32_dpp v32, v33, v33 row_ror:8 row_mask:0xf bank_mask:0xc
  s_waitcnt vmcnt(8)
  buffer_load_dwordx4 v[92:95], v1, s[28:31], s56 offen nt
  s_add_u32 s56, s56, 4096
  v_dot2_f32_bf16 v35, v124, v16, 0
  v_dot2_f32_bf16 v35, v125, v17, v35
  v_dot2_f32_bf16 v35, v126, v18, v35
  v_dot2_f32_bf16 v35, v127, v19, v35
  v_add_f32_dpp v34, v34, v34 row_ror:8 row_mask:0xf bank_mask:0x3
  s_nop 1
  v_add_f32_dpp v34, v35, v35 row_ror:8 row_mask:0xf bank_mask:0xc
  v_add_f32_dpp v32, v32, v32 row_shl:4 row_mask:0xf bank_mask:0x5
  s_nop 1
  v_add_f32_dpp v32, v34, v34 row_shr:4 row_mask:0xf bank_mask:0xa
  v_add_f32_dpp v20, v20, v20 quad_perm:[1,0,3,2] row_mask:0xf bank_mask:0xf
  v_add_f32_dpp v24, v24, v24 quad_perm:[1,0,3,2] row_mask:0xf bank_mask:0xf
  v_add_f32_dpp v28, v28, v28 quad_perm:[1,0,3,2] row_mask:0xf bank_mask:0xf
  v_add_f32_dpp v32, v32, v32 quad_perm:[1,0,3,2] row_mask:0xf bank_mask:0xf
  v_add_f32_dpp v44, v20, v20 quad_perm:[2,3,0,1] row_mask:0xf bank_mask:0xf
  v_add_f32_dpp v45, v24, v24 quad_perm:[2,3,0,1] row_mask:0xf bank_mask:0xf
  v_add_f32_dpp v46, v28, v28 quad_perm:[2,3,0,1] row_mask:0xf bank_mask:0xf
  v_add_f32_dpp v47, v32, v32 quad_perm:[2,3,0,1] row_mask:0xf bank_mask:0xf
  v_mul_f32 v44, s61, v44
  v_mul_f32 v45, s61, v45
  v_mul_f32 v46, s61, v46
  v_mul_f32 v47, s61, v47
  ds_write_b128 v7, v[44:47] offset:7168
  v_max3_f32 v50, v48, v44, v45
  v_max3_f32 v50, v50, v46, v47
  v_sub_f32 v51, v48, v50
  v_sub_f32 v52, v44, v50
  v_sub_f32 v53, v45, v50
  v_sub_f32 v54, v46, v50
  v_sub_f32 v55, v47, v50
  v_exp_f32 v51, v51
  v_exp_f32 v52, v52
  v_exp_f32 v53, v53
  v_exp_f32 v54, v54
  v_exp_f32 v55, v55
  v_mov_b32 v48, v50
  v_add_f32 v52, v52, v53
  v_add_f32 v54, v54, v55
  v_add_f32 v52, v52, v54
  v_fma_f32 v49, v49, v51, v52
  s_waitcnt vmcnt(8)
  v_perm_b32 v38, v252, v248, s59
  v_perm_b32 v252, v252, v248, s60
  v_mov_b32 v248, v38
  v_perm_b32 v39, v253, v249, s59
  v_perm_b32 v253, v253, v249, s60
  v_mov_b32 v249, v39
  v_perm_b32 v38, v254, v250, s59
  v_perm_b32 v254, v254, v250, s60
  v_mov_b32 v250, v38
  v_perm_b32 v39, v255, v251, s59
  v_perm_b32 v255, v255, v251, s60
  v_mov_b32 v251, v39
  ds_read_b128 v[44:47], v7 offset:0
  v_max_f32_dpp v50, v48, v48 row_ror:4 row_mask:0xf bank_mask:0xf
  s_nop 1
  v_max_f32_dpp v50, v50, v50 row_ror:8 row_mask:0xf bank_mask:0xf
  v_mov_b32 v51, v50
  s_nop 1
  v_permlane32_swap_b32 v50, v51
  v_max_f32 v50, v50, v51
  v_mov_b32 v51, v50
  s_nop 1
  v_permlane16_swap_b32 v50, v51
  v_max_f32 v50, v50, v51
  v_sub_f32 v52, v48, v50
  v_exp_f32 v52, v52
  v_mov_b32 v48, v50
  v_mul_f32 v49, v49, v52
  s_nop 1
  v_add_f32_dpp v49, v49, v49 row_ror:4 row_mask:0xf bank_mask:0xf
  s_nop 1
  v_add_f32_dpp v49, v49, v49 row_ror:8 row_mask:0xf bank_mask:0xf
  v_mov_b32 v51, v49
  s_nop 1
  v_permlane32_swap_b32 v49, v51
  v_add_f32 v49, v49, v51
  v_mov_b32 v51, v49
  s_nop 1
  v_permlane16_swap_b32 v49, v51
  v_add_f32 v49, v49, v51
  v_min_u32 v50, -2, v48
  v_min_u32 v51, -2, v49
  v_lshlrev_b32 v62, 3, v58
  ds_write_b64 v62, v[50:51] offset:34048
  v_mov_b32 v63, v7
  s_mov_b32 s62, 0
  v_lshrrev_b32 v62, 1, v61
  v_lshl_add_u32 v62, v58, 3, v62
  v_lshlrev_b32 v62, 13, v62
  v_and_b32 v40, 1, v61
  v_lshl_add_u32 v62, v40, 6, v62
  v_lshl_add_u32 v62, v60, 4, v62
  s_lshl_b32 s65, s53, 18
  s_lshl_b32 s3, s86, 7
  s_add_u32 s65, s65, s3
  s_waitcnt lgkmcnt(0)
L_vloop_standalone__mha_block_cached__decode_kernel:
  v_sub_f32 v20, v44, v48
  v_sub_f32 v21, v45, v48
  v_sub_f32 v22, v46, v48
  v_sub_f32 v23, v47, v48
  v_exp_f32 v20, v20
  v_exp_f32 v21, v21
  v_exp_f32 v22, v22
  v_exp_f32 v23, v23
  v_add_u32 v63, 1024, v63
  ds_read_b128 v[44:47], v63 offset:0
  v_mov_b32_dpp v28, v20 row_newbcast:0 row_mask:0xf bank_mask:0xf
  s_waitcnt vmcnt(7)
  buffer_load_dwordx4 v[96:99], v1, s[28:31], s56 offen nt
  s_add_u32 s56, s56, 4096
  v_lshlrev_b32 v50, 16, v64
  v_and_b32 v51, 0xffff0000, v64
  v_lshlrev_b32 v52, 16, v65
  v_and_b32 v53, 0xffff0000, v65
  v_lshlrev_b32 v54, 16, v66
  v_and_b32 v55, 0xffff0000, v66
  v_lshlrev_b32 v56, 16, v67
  v_and_b32 v57, 0xffff0000, v67
  v_fmac_f32 v8, v28, v50
  v_fmac_f32 v9, v28, v51
  v_fmac_f32 v10, v28, v52
  v_fmac_f32 v11, v28, v53
  v_fmac_f32 v12, v28, v54
  v_fmac_f32 v13, v28, v55
  v_fmac_f32 v14, v28, v56
  v_fmac_f32 v15, v28, v57
  v_mov_b32_dpp v29, v20 row_newbcast:8 row_mask:0xf bank_mask:0xf
  s_waitcnt vmcnt(7)
  buffer_load_dwordx4 v[100:103], v1, s[28:31], s56 offen nt
  s_add_u32 s56, s56, 4096
  v_lshlrev_b32 v50, 16, v68
  v_and_b32 v51, 0xffff0000, v68
  v_lshlrev_b32 v52, 16, v69
  v_and_b32 v53, 0xffff0000, v69
  v_lshlrev_b32 v54, 16, v70
  v_and_b32 v55, 0xffff0000, v70
  v_lshlrev_b32 v56, 16, v71
  v_and_b32 v57, 0xffff0000, v71
  v_fmac_f32 v8, v29, v50
  v_fmac_f32 v9, v29, v51
  v_fmac_f32 v10, v29, v52
  v_fmac_f32 v11, v29, v53
  v_fmac_f32 v12, v29, v54
  v_fmac_f32 v13, v29, v55
  v_fmac_f32 v14, v29, v56
  v_fmac_f32 v15, v29, v57
  v_mov_b32_dpp v28, v20 row_newbcast:4 row_mask:0xf bank_mask:0xf
  s_waitcnt vmcnt(7)
  buffer_load_dwordx4 v[104:107], v1, s[28:31], s56 offen nt
  s_add_u32 s56, s56, 4096
  v_lshlrev_b32 v50, 16, v72
  v_and_b32 v51, 0xffff0000, v72
  v_lshlrev_b32 v52, 16, v73
  v_and_b32 v53, 0xffff0000, v73
  v_lshlrev_b32 v54, 16, v74
  v_and_b32 v55, 0xffff0000, v74
  v_lshlrev_b32 v56, 16, v75
  v_and_b32 v57, 0xffff0000, v75
  v_fmac_f32 v8, v28, v50
  v_fmac_f32 v9, v28, v51
  v_fmac_f32 v10, v28, v52
  v_fmac_f32 v11, v28, v53
  v_fmac_f32 v12, v28, v54
  v_fmac_f32 v13, v28, v55
  v_fmac_f32 v14, v28, v56
  v_fmac_f32 v15, v28, v57
  v_mov_b32_dpp v29, v20 row_newbcast:12 row_mask:0xf bank_mask:0xf
  s_waitcnt vmcnt(7)
  buffer_load_dwordx4 v[108:111], v1, s[28:31], s56 offen nt
  s_add_u32 s56, s56, 4096
  v_lshlrev_b32 v50, 16, v76
  v_and_b32 v51, 0xffff0000, v76
  v_lshlrev_b32 v52, 16, v77
  v_and_b32 v53, 0xffff0000, v77
  v_lshlrev_b32 v54, 16, v78
  v_and_b32 v55, 0xffff0000, v78
  v_lshlrev_b32 v56, 16, v79
  v_and_b32 v57, 0xffff0000, v79
  v_fmac_f32 v8, v29, v50
  v_fmac_f32 v9, v29, v51
  v_fmac_f32 v10, v29, v52
  v_fmac_f32 v11, v29, v53
  v_fmac_f32 v12, v29, v54
  v_fmac_f32 v13, v29, v55
  v_fmac_f32 v14, v29, v56
  v_fmac_f32 v15, v29, v57
  v_mov_b32_dpp v28, v21 row_newbcast:0 row_mask:0xf bank_mask:0xf
  s_waitcnt vmcnt(7)
  buffer_load_dwordx4 v[112:115], v1, s[28:31], s56 offen nt
  s_add_u32 s56, s56, 4096
  v_lshlrev_b32 v50, 16, v80
  v_and_b32 v51, 0xffff0000, v80
  v_lshlrev_b32 v52, 16, v81
  v_and_b32 v53, 0xffff0000, v81
  v_lshlrev_b32 v54, 16, v82
  v_and_b32 v55, 0xffff0000, v82
  v_lshlrev_b32 v56, 16, v83
  v_and_b32 v57, 0xffff0000, v83
  v_fmac_f32 v8, v28, v50
  v_fmac_f32 v9, v28, v51
  v_fmac_f32 v10, v28, v52
  v_fmac_f32 v11, v28, v53
  v_fmac_f32 v12, v28, v54
  v_fmac_f32 v13, v28, v55
  v_fmac_f32 v14, v28, v56
  v_fmac_f32 v15, v28, v57
  v_mov_b32_dpp v29, v21 row_newbcast:8 row_mask:0xf bank_mask:0xf
  s_waitcnt vmcnt(7)
  buffer_load_dwordx4 v[116:119], v1, s[28:31], s56 offen nt
  s_add_u32 s56, s56, 4096
  v_lshlrev_b32 v50, 16, v84
  v_and_b32 v51, 0xffff0000, v84
  v_lshlrev_b32 v52, 16, v85
  v_and_b32 v53, 0xffff0000, v85
  v_lshlrev_b32 v54, 16, v86
  v_and_b32 v55, 0xffff0000, v86
  v_lshlrev_b32 v56, 16, v87
  v_and_b32 v57, 0xffff0000, v87
  v_fmac_f32 v8, v29, v50
  v_fmac_f32 v9, v29, v51
  v_fmac_f32 v10, v29, v52
  v_fmac_f32 v11, v29, v53
  v_fmac_f32 v12, v29, v54
  v_fmac_f32 v13, v29, v55
  v_fmac_f32 v14, v29, v56
  v_fmac_f32 v15, v29, v57
  v_mov_b32_dpp v28, v21 row_newbcast:4 row_mask:0xf bank_mask:0xf
  s_waitcnt vmcnt(7)
  buffer_load_dwordx4 v[120:123], v1, s[28:31], s56 offen nt
  s_add_u32 s56, s56, 4096
  v_lshlrev_b32 v50, 16, v88
  v_and_b32 v51, 0xffff0000, v88
  v_lshlrev_b32 v52, 16, v89
  v_and_b32 v53, 0xffff0000, v89
  v_lshlrev_b32 v54, 16, v90
  v_and_b32 v55, 0xffff0000, v90
  v_lshlrev_b32 v56, 16, v91
  v_and_b32 v57, 0xffff0000, v91
  v_fmac_f32 v8, v28, v50
  v_fmac_f32 v9, v28, v51
  v_fmac_f32 v10, v28, v52
  v_fmac_f32 v11, v28, v53
  v_fmac_f32 v12, v28, v54
  v_fmac_f32 v13, v28, v55
  v_fmac_f32 v14, v28, v56
  v_fmac_f32 v15, v28, v57
  v_mov_b32_dpp v29, v21 row_newbcast:12 row_mask:0xf bank_mask:0xf
  s_waitcnt vmcnt(7)
  buffer_load_dwordx4 v[124:127], v1, s[28:31], s56 offen nt
  s_add_u32 s56, s56, 4096
  v_lshlrev_b32 v50, 16, v92
  v_and_b32 v51, 0xffff0000, v92
  v_lshlrev_b32 v52, 16, v93
  v_and_b32 v53, 0xffff0000, v93
  v_lshlrev_b32 v54, 16, v94
  v_and_b32 v55, 0xffff0000, v94
  v_lshlrev_b32 v56, 16, v95
  v_and_b32 v57, 0xffff0000, v95
  v_fmac_f32 v8, v29, v50
  v_fmac_f32 v9, v29, v51
  v_fmac_f32 v10, v29, v52
  v_fmac_f32 v11, v29, v53
  v_fmac_f32 v12, v29, v54
  v_fmac_f32 v13, v29, v55
  v_fmac_f32 v14, v29, v56
  v_fmac_f32 v15, v29, v57
  v_mov_b32_dpp v28, v22 row_newbcast:0 row_mask:0xf bank_mask:0xf
  s_waitcnt vmcnt(7)
  buffer_load_dwordx4 v[64:67], v1, s[28:31], s56 offen nt
  s_add_u32 s56, s56, 4096
  v_lshlrev_b32 v50, 16, v96
  v_and_b32 v51, 0xffff0000, v96
  v_lshlrev_b32 v52, 16, v97
  v_and_b32 v53, 0xffff0000, v97
  v_lshlrev_b32 v54, 16, v98
  v_and_b32 v55, 0xffff0000, v98
  v_lshlrev_b32 v56, 16, v99
  v_and_b32 v57, 0xffff0000, v99
  v_fmac_f32 v8, v28, v50
  v_fmac_f32 v9, v28, v51
  v_fmac_f32 v10, v28, v52
  v_fmac_f32 v11, v28, v53
  v_fmac_f32 v12, v28, v54
  v_fmac_f32 v13, v28, v55
  v_fmac_f32 v14, v28, v56
  v_fmac_f32 v15, v28, v57
  v_mov_b32_dpp v29, v22 row_newbcast:8 row_mask:0xf bank_mask:0xf
  s_waitcnt vmcnt(7)
  buffer_load_dwordx4 v[68:71], v1, s[28:31], s56 offen nt
  s_add_u32 s56, s56, 4096
  v_lshlrev_b32 v50, 16, v100
  v_and_b32 v51, 0xffff0000, v100
  v_lshlrev_b32 v52, 16, v101
  v_and_b32 v53, 0xffff0000, v101
  v_lshlrev_b32 v54, 16, v102
  v_and_b32 v55, 0xffff0000, v102
  v_lshlrev_b32 v56, 16, v103
  v_and_b32 v57, 0xffff0000, v103
  v_fmac_f32 v8, v29, v50
  v_fmac_f32 v9, v29, v51
  v_fmac_f32 v10, v29, v52
  v_fmac_f32 v11, v29, v53
  v_fmac_f32 v12, v29, v54
  v_fmac_f32 v13, v29, v55
  v_fmac_f32 v14, v29, v56
  v_fmac_f32 v15, v29, v57
  v_mov_b32_dpp v28, v22 row_newbcast:4 row_mask:0xf bank_mask:0xf
  s_waitcnt vmcnt(7)
  buffer_load_dwordx4 v[72:75], v1, s[28:31], s56 offen nt
  s_add_u32 s56, s56, 4096
  v_lshlrev_b32 v50, 16, v104
  v_and_b32 v51, 0xffff0000, v104
  v_lshlrev_b32 v52, 16, v105
  v_and_b32 v53, 0xffff0000, v105
  v_lshlrev_b32 v54, 16, v106
  v_and_b32 v55, 0xffff0000, v106
  v_lshlrev_b32 v56, 16, v107
  v_and_b32 v57, 0xffff0000, v107
  v_fmac_f32 v8, v28, v50
  v_fmac_f32 v9, v28, v51
  v_fmac_f32 v10, v28, v52
  v_fmac_f32 v11, v28, v53
  v_fmac_f32 v12, v28, v54
  v_fmac_f32 v13, v28, v55
  v_fmac_f32 v14, v28, v56
  v_fmac_f32 v15, v28, v57
  v_mov_b32_dpp v29, v22 row_newbcast:12 row_mask:0xf bank_mask:0xf
  s_waitcnt vmcnt(7)
  buffer_load_dwordx4 v[76:79], v1, s[28:31], s56 offen nt
  s_add_u32 s56, s56, 4096
  v_lshlrev_b32 v50, 16, v108
  v_and_b32 v51, 0xffff0000, v108
  v_lshlrev_b32 v52, 16, v109
  v_and_b32 v53, 0xffff0000, v109
  v_lshlrev_b32 v54, 16, v110
  v_and_b32 v55, 0xffff0000, v110
  v_lshlrev_b32 v56, 16, v111
  v_and_b32 v57, 0xffff0000, v111
  v_fmac_f32 v8, v29, v50
  v_fmac_f32 v9, v29, v51
  v_fmac_f32 v10, v29, v52
  v_fmac_f32 v11, v29, v53
  v_fmac_f32 v12, v29, v54
  v_fmac_f32 v13, v29, v55
  v_fmac_f32 v14, v29, v56
  v_fmac_f32 v15, v29, v57
  v_mov_b32_dpp v28, v23 row_newbcast:0 row_mask:0xf bank_mask:0xf
  s_waitcnt vmcnt(7)
  buffer_load_dwordx4 v[80:83], v1, s[28:31], s56 offen nt
  s_add_u32 s56, s56, 4096
  v_lshlrev_b32 v50, 16, v112
  v_and_b32 v51, 0xffff0000, v112
  v_lshlrev_b32 v52, 16, v113
  v_and_b32 v53, 0xffff0000, v113
  v_lshlrev_b32 v54, 16, v114
  v_and_b32 v55, 0xffff0000, v114
  v_lshlrev_b32 v56, 16, v115
  v_and_b32 v57, 0xffff0000, v115
  v_fmac_f32 v8, v28, v50
  v_fmac_f32 v9, v28, v51
  v_fmac_f32 v10, v28, v52
  v_fmac_f32 v11, v28, v53
  v_fmac_f32 v12, v28, v54
  v_fmac_f32 v13, v28, v55
  v_fmac_f32 v14, v28, v56
  v_fmac_f32 v15, v28, v57
  v_mov_b32_dpp v29, v23 row_newbcast:8 row_mask:0xf bank_mask:0xf
  s_waitcnt vmcnt(7)
  buffer_load_dwordx4 v[84:87], v1, s[28:31], s56 offen nt
  s_add_u32 s56, s56, 4096
  v_lshlrev_b32 v50, 16, v116
  v_and_b32 v51, 0xffff0000, v116
  v_lshlrev_b32 v52, 16, v117
  v_and_b32 v53, 0xffff0000, v117
  v_lshlrev_b32 v54, 16, v118
  v_and_b32 v55, 0xffff0000, v118
  v_lshlrev_b32 v56, 16, v119
  v_and_b32 v57, 0xffff0000, v119
  v_fmac_f32 v8, v29, v50
  v_fmac_f32 v9, v29, v51
  v_fmac_f32 v10, v29, v52
  v_fmac_f32 v11, v29, v53
  v_fmac_f32 v12, v29, v54
  v_fmac_f32 v13, v29, v55
  v_fmac_f32 v14, v29, v56
  v_fmac_f32 v15, v29, v57
  v_mov_b32_dpp v28, v23 row_newbcast:4 row_mask:0xf bank_mask:0xf
  s_waitcnt vmcnt(7)
  buffer_load_dwordx4 v[88:91], v1, s[28:31], s56 offen nt
  s_add_u32 s56, s56, 4096
  v_lshlrev_b32 v50, 16, v120
  v_and_b32 v51, 0xffff0000, v120
  v_lshlrev_b32 v52, 16, v121
  v_and_b32 v53, 0xffff0000, v121
  v_lshlrev_b32 v54, 16, v122
  v_and_b32 v55, 0xffff0000, v122
  v_lshlrev_b32 v56, 16, v123
  v_and_b32 v57, 0xffff0000, v123
  v_fmac_f32 v8, v28, v50
  v_fmac_f32 v9, v28, v51
  v_fmac_f32 v10, v28, v52
  v_fmac_f32 v11, v28, v53
  v_fmac_f32 v12, v28, v54
  v_fmac_f32 v13, v28, v55
  v_fmac_f32 v14, v28, v56
  v_fmac_f32 v15, v28, v57
  v_mov_b32_dpp v29, v23 row_newbcast:12 row_mask:0xf bank_mask:0xf
  s_waitcnt vmcnt(7)
  buffer_load_dwordx4 v[92:95], v1, s[28:31], s56 offen nt
  s_add_u32 s56, s56, 4096
  v_lshlrev_b32 v50, 16, v124
  v_and_b32 v51, 0xffff0000, v124
  v_lshlrev_b32 v52, 16, v125
  v_and_b32 v53, 0xffff0000, v125
  v_lshlrev_b32 v54, 16, v126
  v_and_b32 v55, 0xffff0000, v126
  v_lshlrev_b32 v56, 16, v127
  v_and_b32 v57, 0xffff0000, v127
  v_fmac_f32 v8, v29, v50
  v_fmac_f32 v9, v29, v51
  v_fmac_f32 v10, v29, v52
  v_fmac_f32 v11, v29, v53
  v_fmac_f32 v12, v29, v54
  v_fmac_f32 v13, v29, v55
  v_fmac_f32 v14, v29, v56
  v_fmac_f32 v15, v29, v57
  s_add_u32 s62, s62, 1
  v_mov_b32 v40, s62
  ds_write_b32 v41, v40 offset:34080
  s_cmp_lt_u32 s62, 8
  s_waitcnt lgkmcnt(0)
  s_cbranch_scc1 L_vloop_standalone__mha_block_cached__decode_kernel
  v_permlane32_swap_b32 v8, v12
  v_permlane32_swap_b32 v9, v13
  v_permlane32_swap_b32 v10, v14
  v_permlane32_swap_b32 v11, v15
  v_add_f32 v8, v8, v12
  v_add_f32 v9, v9, v13
  v_add_f32 v10, v10, v14
  v_add_f32 v11, v11, v15
  s_nop 0
  v_permlane16_swap_b32 v8, v10
  v_permlane16_swap_b32 v9, v11
  v_add_f32 v8, v8, v10
  v_add_f32 v10, v9, v11
  v_mov_b32 v9, v10
  ds_write_b64 v5, v[8:9] offset:34112
  s_waitcnt lgkmcnt(0)
  s_barrier
  ds_read_b128 v[32:35], v41 offset:34096
  ds_read2_b32 v[50:51], v43 offset0:0 offset1:4
  ds_read2_b32 v[52:53], v43 offset0:128 offset1:132
  ds_read2_b32 v[54:55], v37 offset0:0 offset1:4
  ds_read2_b32 v[56:57], v37 offset0:128 offset1:132
  v_mov_b32 v8, 0
  v_mov_b32 v9, 0
  v_mov_b32 v10, 0
  v_mov_b32 v11, 0
  v_mov_b32 v12, 0
  v_mov_b32 v13, 0
  v_mov_b32 v14, 0
  v_mov_b32 v15, 0
  s_waitcnt lgkmcnt(0)
  v_mul_f32 v28, v32, v50
  v_mul_f32 v29, v32, v51
  v_fmac_f32 v28, v33, v52
  v_fmac_f32 v29, v33, v53
  v_fmac_f32 v28, v34, v54
  v_fmac_f32 v29, v34, v55
  v_fmac_f32 v28, v35, v56
  v_fmac_f32 v29, v35, v57
  v_cvt_pk_bf16_f32 v36, v28, v29
  s_nop 1
  v_mov_b32_dpp v38, v36 row_newbcast:0 row_mask:0xf bank_mask:0xf
  v_dot2c_f32_bf16 v8, v38, v128
  v_dot2c_f32_bf16 v9, v38, v132
  v_dot2c_f32_bf16 v10, v38, v129
  v_dot2c_f32_bf16 v11, v38, v133
  v_dot2c_f32_bf16 v12, v38, v130
  v_dot2c_f32_bf16 v13, v38, v134
  v_dot2c_f32_bf16 v14, v38, v131
  v_dot2c_f32_bf16 v15, v38, v135
  v_mov_b32_dpp v39, v36 row_newbcast:1 row_mask:0xf bank_mask:0xf
  v_dot2c_f32_bf16 v8, v39, v136
  v_dot2c_f32_bf16 v9, v39, v140
  v_dot2c_f32_bf16 v10, v39, v137
  v_dot2c_f32_bf16 v11, v39, v141
  v_dot2c_f32_bf16 v12, v39, v138
  v_dot2c_f32_bf16 v13, v39, v142
  v_dot2c_f32_bf16 v14, v39, v139
  v_dot2c_f32_bf16 v15, v39, v143
  v_mov_b32_dpp v38, v36 row_newbcast:2 row_mask:0xf bank_mask:0xf
  v_dot2c_f32_bf16 v8, v38, v144
  v_dot2c_f32_bf16 v9, v38, v148
  v_dot2c_f32_bf16 v10, v38, v145
  v_dot2c_f32_bf16 v11, v38, v149
  v_dot2c_f32_bf16 v12, v38, v146
  v_dot2c_f32_bf16 v13, v38, v150
  v_dot2c_f32_bf16 v14, v38, v147
  v_dot2c_f32_bf16 v15, v38, v151
  v_mov_b32_dpp v39, v36 row_newbcast:3 row_mask:0xf bank_mask:0xf
  v_dot2c_f32_bf16 v8, v39, v152
  v_dot2c_f32_bf16 v9, v39, v156
  v_dot2c_f32_bf16 v10, v39, v153
  v_dot2c_f32_bf16 v11, v39, v157
  v_dot2c_f32_bf16 v12, v39, v154
  v_dot2c_f32_bf16 v13, v39, v158
  v_dot2c_f32_bf16 v14, v39, v155
  v_dot2c_f32_bf16 v15, v39, v159
  v_mov_b32_dpp v38, v36 row_newbcast:4 row_mask:0xf bank_mask:0xf
  v_dot2c_f32_bf16 v8, v38, v160
  v_dot2c_f32_bf16 v9, v38, v164
  v_dot2c_f32_bf16 v10, v38, v161
  v_dot2c_f32_bf16 v11, v38, v165
  v_dot2c_f32_bf16 v12, v38, v162
  v_dot2c_f32_bf16 v13, v38, v166
  v_dot2c_f32_bf16 v14, v38, v163
  v_dot2c_f32_bf16 v15, v38, v167
  v_mov_b32_dpp v39, v36 row_newbcast:5 row_mask:0xf bank_mask:0xf
  v_dot2c_f32_bf16 v8, v39, v168
  v_dot2c_f32_bf16 v9, v39, v172
  v_dot2c_f32_bf16 v10, v39, v169
  v_dot2c_f32_bf16 v11, v39, v173
  v_dot2c_f32_bf16 v12, v39, v170
  v_dot2c_f32_bf16 v13, v39, v174
  v_dot2c_f32_bf16 v14, v39, v171
  v_dot2c_f32_bf16 v15, v39, v175
  v_mov_b32_dpp v38, v36 row_newbcast:6 row_mask:0xf bank_mask:0xf
  v_dot2c_f32_bf16 v8, v38, v176
  v_dot2c_f32_bf16 v9, v38, v180
  v_dot2c_f32_bf16 v10, v38, v177
  v_dot2c_f32_bf16 v11, v38, v181
  v_dot2c_f32_bf16 v12, v38, v178
  v_dot2c_f32_bf16 v13, v38, v182
  v_dot2c_f32_bf16 v14, v38, v179
  v_dot2c_f32_bf16 v15, v38, v183
  v_mov_b32_dpp v39, v36 row_newbcast:7 row_mask:0xf bank_mask:0xf
  v_dot2c_f32_bf16 v8, v39, v184
  v_dot2c_f32_bf16 v9, v39, v188
  v_dot2c_f32_bf16 v10, v39, v185
  v_dot2c_f32_bf16 v11, v39, v189
  v_dot2c_f32_bf16 v12, v39, v186
  v_dot2c_f32_bf16 v13, v39, v190
  v_dot2c_f32_bf16 v14, v39, v187
  v_dot2c_f32_bf16 v15, v39, v191
  v_mov_b32_dpp v38, v36 row_newbcast:8 row_mask:0xf bank_mask:0xf
  v_dot2c_f32_bf16 v8, v38, v192
  v_dot2c_f32_bf16 v9, v38, v196
  v_dot2c_f32_bf16 v10, v38, v193
  v_dot2c_f32_bf16 v11, v38, v197
  v_dot2c_f32_bf16 v12, v38, v194
  v_dot2c_f32_bf16 v13, v38, v198
  v_dot2c_f32_bf16 v14, v38, v195
  v_dot2c_f32_bf16 v15, v38, v199
  v_mov_b32_dpp v39, v36 row_newbcast:9 row_mask:0xf bank_mask:0xf
  v_dot2c_f32_bf16 v8, v39, v200
  v_dot2c_f32_bf16 v9, v39, v204
  v_dot2c_f32_bf16 v10, v39, v201
  v_dot2c_f32_bf16 v11, v39, v205
  v_dot2c_f32_bf16 v12, v39, v202
  v_dot2c_f32_bf16 v13, v39, v206
  v_dot2c_f32_bf16 v14, v39, v203
  v_dot2c_f32_bf16 v15, v39, v207
  v_mov_b32_dpp v38, v36 row_newbcast:10 row_mask:0xf bank_mask:0xf
  v_dot2c_f32_bf16 v8, v38, v208
  v_dot2c_f32_bf16 v9, v38, v212
  v_dot2c_f32_bf16 v10, v38, v209
  v_dot2c_f32_bf16 v11, v38, v213
  v_dot2c_f32_bf16 v12, v38, v210
  v_dot2c_f32_bf16 v13, v38, v214
  v_dot2c_f32_bf16 v14, v38, v211
  v_dot2c_f32_bf16 v15, v38, v215
  v_mov_b32_dpp v39, v36 row_newbcast:11 row_mask:0xf bank_mask:0xf
  v_dot2c_f32_bf16 v8, v39, v216
  v_dot2c_f32_bf16 v9, v39, v220
  v_dot2c_f32_bf16 v10, v39, v217
  v_dot2c_f32_bf16 v11, v39, v221
  v_dot2c_f32_bf16 v12, v39, v218
  v_dot2c_f32_bf16 v13, v39, v222
  v_dot2c_f32_bf16 v14, v39, v219
  v_dot2c_f32_bf16 v15, v39, v223
  v_mov_b32_dpp v38, v36 row_newbcast:12 row_mask:0xf bank_mask:0xf
  v_dot2c_f32_bf16 v8, v38, v224
  v_dot2c_f32_bf16 v9, v38, v228
  v_dot2c_f32_bf16 v10, v38, v225
  v_dot2c_f32_bf16 v11, v38, v229
  v_dot2c_f32_bf16 v12, v38, v226
  v_dot2c_f32_bf16 v13, v38, v230
  v_dot2c_f32_bf16 v14, v38, v227
  v_dot2c_f32_bf16 v15, v38, v231
  v_mov_b32_dpp v39, v36 row_newbcast:13 row_mask:0xf bank_mask:0xf
  v_dot2c_f32_bf16 v8, v39, v232
  v_dot2c_f32_bf16 v9, v39, v236
  v_dot2c_f32_bf16 v10, v39, v233
  v_dot2c_f32_bf16 v11, v39, v237
  v_dot2c_f32_bf16 v12, v39, v234
  v_dot2c_f32_bf16 v13, v39, v238
  v_dot2c_f32_bf16 v14, v39, v235
  v_dot2c_f32_bf16 v15, v39, v239
  v_mov_b32_dpp v38, v36 row_newbcast:14 row_mask:0xf bank_mask:0xf
  v_dot2c_f32_bf16 v8, v38, v240
  v_dot2c_f32_bf16 v9, v38, v244
  v_dot2c_f32_bf16 v10, v38, v241
  v_dot2c_f32_bf16 v11, v38, v245
  v_dot2c_f32_bf16 v12, v38, v242
  v_dot2c_f32_bf16 v13, v38, v246
  v_dot2c_f32_bf16 v14, v38, v243
  v_dot2c_f32_bf16 v15, v38, v247
  v_mov_b32_dpp v39, v36 row_newbcast:15 row_mask:0xf bank_mask:0xf
  v_dot2c_f32_bf16 v8, v39, v248
  v_dot2c_f32_bf16 v9, v39, v252
  v_dot2c_f32_bf16 v10, v39, v249
  v_dot2c_f32_bf16 v11, v39, v253
  v_dot2c_f32_bf16 v12, v39, v250
  v_dot2c_f32_bf16 v13, v39, v254
  v_dot2c_f32_bf16 v14, v39, v251
  v_dot2c_f32_bf16 v15, v39, v255
  v_permlane32_swap_b32 v8, v12
  v_permlane32_swap_b32 v9, v13
  v_permlane32_swap_b32 v10, v14
  v_permlane32_swap_b32 v11, v15
  v_add_f32 v8, v8, v12
  v_add_f32 v9, v9, v13
  v_add_f32 v10, v10, v14
  v_add_f32 v11, v11, v15
  s_nop 0
  v_permlane16_swap_b32 v8, v10
  v_permlane16_swap_b32 v9, v11
  v_add_f32 v8, v8, v10
  v_add_f32 v10, v9, v11
  v_mov_b32 v9, v42
  v_mov_b32 v11, v42
  buffer_store_dwordx4 v[8:11], v62, s[48:51], s65 offen sc1
  s_endpgm
  s_nop 0
L_helper_standalone__mha_block_cached__decode_kernel:
  v_lshlrev_b32 v6, 4, v59
  v_lshlrev_b32 v2, 17, v60
  v_lshl_add_u32 v2, v61, 4, v2
  s_lshl_b32 s57, s82, 19
  s_lshl_b32 s3, s52, 8
  s_add_u32 s57, s57, s3
  v_lshrrev_b32 v62, 3, v61
  v_lshlrev_b32 v62, 10, v62
  v_lshl_add_u32 v62, v60, 5, v62
  v_and_b32 v4, 7, v61
  v_lshl_add_u32 v62, v4, 2, v62
  s_lshl_b32 s65, s82, 7
  s_mov_b32 s22, 4096
  s_mov_b32 s23, 0x20000
  s_mov_b32 s34, 4194304
  s_mov_b32 s35, 0x20000
  v_mov_b32 v20, -1
  v_mov_b32 v21, -1
  v_mov_b32 v22, -1
  v_mov_b32 v23, -1
  v_mov_b32 v63, 0
  v_mov_b32 v24, 0
  v_mov_b32 v25, 0
  ds_write_b128 v63, v[20:23] offset:34048
  ds_write_b128 v63, v[20:23] offset:34064
  ds_write_b64 v63, v[24:25] offset:34080
  s_waitcnt lgkmcnt(0)
  s_mov_b32 s32, s10
  s_mov_b32 s33, s11
  s_mov_b32 s20, s4
  s_mov_b32 s21, s5
  buffer_load_dwordx4 v[64:67], v2, s[32:35], s57 offen nt
  s_add_u32 s57, s57, 8192
  buffer_load_dword v4, v62, s[20:23], s65 offen
  buffer_load_dword v7, v62, s[20:23], s65 offen offset:2048
  buffer_load_dwordx4 v[68:71], v2, s[32:35], s57 offen nt
  s_add_u32 s57, s57, 8192
  buffer_load_dwordx4 v[72:75], v2, s[32:35], s57 offen nt
  s_add_u32 s57, s57, 8192
  buffer_load_dwordx4 v[76:79], v2, s[32:35], s57 offen nt
  s_add_u32 s57, s57, 8192
  buffer_load_dwordx4 v[80:83], v2, s[32:35], s57 offen nt
  s_add_u32 s57, s57, 8192
  buffer_load_dwordx4 v[84:87], v2, s[32:35], s57 offen nt
  s_add_u32 s57, s57, 8192
  buffer_load_dwordx4 v[88:91], v2, s[32:35], s57 offen nt
  s_add_u32 s57, s57, 8192
  buffer_load_dwordx4 v[92:95], v2, s[32:35], s57 offen nt
  s_add_u32 s57, s57, 8192
  buffer_load_dwordx4 v[96:99], v2, s[32:35], s57 offen nt
  s_add_u32 s57, s57, 8192
  buffer_load_dwordx4 v[100:103], v2, s[32:35], s57 offen nt
  s_add_u32 s57, s57, 8192
  buffer_load_dwordx4 v[104:107], v2, s[32:35], s57 offen nt
  s_add_u32 s57, s57, 8192
  buffer_load_dwordx4 v[108:111], v2, s[32:35], s57 offen nt
  s_add_u32 s57, s57, 8192
  buffer_load_dwordx4 v[112:115], v2, s[32:35], s57 offen nt
  s_add_u32 s57, s57, 8192
  buffer_load_dwordx4 v[116:119], v2, s[32:35], s57 offen nt
  s_add_u32 s57, s57, 8192
  buffer_load_dwordx4 v[120:123], v2, s[32:35], s57 offen nt
  s_add_u32 s57, s57, 8192
  buffer_load_dwordx4 v[124:127], v2, s[32:35], s57 offen nt
  s_add_u32 s42, s18, 3145728
  s_addc_u32 s43, s19, 0
  s_load_dword s45, s[42:43], 0
  s_barrier
  s_mov_b32 s48, s18
  s_mov_b32 s49, s19
  s_mov_b32 s50, 536870912
  s_mov_b32 s51, 0x20000
  s_mov_b32 s36, s14
  s_mov_b32 s37, s15
  s_mov_b32 s38, 4096
  s_mov_b32 s39, 0x20000
  s_mov_b32 s59, 0x05040100
  s_mov_b32 s60, 0x07060302
  v_mov_b32 v128, 0
  v_mov_b32 v129, 0
  v_mov_b32 v130, 0
  v_mov_b32 v131, 0
  v_mov_b32 v132, 0
  v_mov_b32 v133, 0
  v_mov_b32 v134, 0
  v_mov_b32 v135, 0
  v_mov_b32 v136, 0
  v_mov_b32 v137, 0
  v_mov_b32 v138, 0
  v_mov_b32 v139, 0
  v_mov_b32 v140, 0
  v_mov_b32 v141, 0
  v_mov_b32 v142, 0
  v_mov_b32 v143, 0
  v_mov_b32 v144, 0
  v_mov_b32 v145, 0
  v_mov_b32 v146, 0
  v_mov_b32 v147, 0
  v_mov_b32 v148, 0
  v_mov_b32 v149, 0
  v_mov_b32 v150, 0
  v_mov_b32 v151, 0
  v_mov_b32 v152, 0
  v_mov_b32 v153, 0
  v_mov_b32 v154, 0
  v_mov_b32 v155, 0
  v_mov_b32 v156, 0
  v_mov_b32 v157, 0
  v_mov_b32 v158, 0
  v_mov_b32 v159, 0
  v_lshlrev_b32 v24, 6, v61
  v_lshl_add_u32 v24, v60, 4, v24
  s_lshl_b32 s3, s52, 15
  s_lshl_b32 s65, s82, 10
  s_add_u32 s65, s65, s3
  s_add_u32 s65, s65, 2097152
  s_lshl_b32 s66, s53, 13
  s_add_u32 s66, s66, s3
  s_add_u32 s66, s66, 2097152
  s_add_u32 s67, s66, 4096
  s_waitcnt lgkmcnt(0)
  s_mul_i32 s45, s45, 0x9e3779b1
  s_add_u32 s45, s45, 0x7f4a7c15
  s_waitcnt vmcnt(14)
  v_mov_b32_dpp v40, v4 row_newbcast:0 row_mask:0xf bank_mask:0xf
  v_mov_b32_dpp v41, v4 row_newbcast:8 row_mask:0xf bank_mask:0xf
  v_mov_b32_dpp v42, v7 row_newbcast:0 row_mask:0xf bank_mask:0xf
  v_mov_b32_dpp v43, v7 row_newbcast:8 row_mask:0xf bank_mask:0xf
  v_perm_b32 v50, v68, v64, s59
  v_perm_b32 v51, v68, v64, s60
  v_perm_b32 v52, v69, v65, s59
  v_perm_b32 v53, v69, v65, s60
  v_perm_b32 v54, v70, v66, s59
  v_perm_b32 v55, v70, v66, s60
  v_perm_b32 v56, v71, v67, s59
  v_perm_b32 v57, v71, v67, s60
  v_dot2c_f32_bf16 v128, v40, v50
  v_dot2c_f32_bf16 v129, v40, v51
  v_dot2c_f32_bf16 v130, v40, v52
  v_dot2c_f32_bf16 v131, v40, v53
  v_dot2c_f32_bf16 v132, v40, v54
  v_dot2c_f32_bf16 v133, v40, v55
  v_dot2c_f32_bf16 v134, v40, v56
  v_dot2c_f32_bf16 v135, v40, v57
  v_dot2c_f32_bf16 v136, v41, v50
  v_dot2c_f32_bf16 v137, v41, v51
  v_dot2c_f32_bf16 v138, v41, v52
  v_dot2c_f32_bf16 v139, v41, v53
  v_dot2c_f32_bf16 v140, v41, v54
  v_dot2c_f32_bf16 v141, v41, v55
  v_dot2c_f32_bf16 v142, v41, v56
  v_dot2c_f32_bf16 v143, v41, v57
  v_dot2c_f32_bf16 v144, v42, v50
  v_dot2c_f32_bf16 v145, v42, v51
  v_dot2c_f32_bf16 v146, v42, v52
  v_dot2c_f32_bf16 v147, v42, v53
  v_dot2c_f32_bf16 v148, v42, v54
  v_dot2c_f32_bf16 v149, v42, v55
  v_dot2c_f32_bf16 v150, v42, v56
  v_dot2c_f32_bf16 v151, v42, v57
  v_dot2c_f32_bf16 v152, v43, v50
  v_dot2c_f32_bf16 v153, v43, v51
  v_dot2c_f32_bf16 v154, v43, v52
  v_dot2c_f32_bf16 v155, v43, v53
  v_dot2c_f32_bf16 v156, v43, v54
  v_dot2c_f32_bf16 v157, v43, v55
  v_dot2c_f32_bf16 v158, v43, v56
  v_dot2c_f32_bf16 v159, v43, v57
  s_waitcnt vmcnt(12)
  v_mov_b32_dpp v40, v4 row_newbcast:1 row_mask:0xf bank_mask:0xf
  v_mov_b32_dpp v41, v4 row_newbcast:9 row_mask:0xf bank_mask:0xf
  v_mov_b32_dpp v42, v7 row_newbcast:1 row_mask:0xf bank_mask:0xf
  v_mov_b32_dpp v43, v7 row_newbcast:9 row_mask:0xf bank_mask:0xf
  v_perm_b32 v50, v76, v72, s59
  v_perm_b32 v51, v76, v72, s60
  v_perm_b32 v52, v77, v73, s59
  v_perm_b32 v53, v77, v73, s60
  v_perm_b32 v54, v78, v74, s59
  v_perm_b32 v55, v78, v74, s60
  v_perm_b32 v56, v79, v75, s59
  v_perm_b32 v57, v79, v75, s60
  v_dot2c_f32_bf16 v128, v40, v50
  v_dot2c_f32_bf16 v129, v40, v51
  v_dot2c_f32_bf16 v130, v40, v52
  v_dot2c_f32_bf16 v131, v40, v53
  v_dot2c_f32_bf16 v132, v40, v54
  v_dot2c_f32_bf16 v133, v40, v55
  v_dot2c_f32_bf16 v134, v40, v56
  v_dot2c_f32_bf16 v135, v40, v57
  v_dot2c_f32_bf16 v136, v41, v50
  v_dot2c_f32_bf16 v137, v41, v51
  v_dot2c_f32_bf16 v138, v41, v52
  v_dot2c_f32_bf16 v139, v41, v53
  v_dot2c_f32_bf16 v140, v41, v54
  v_dot2c_f32_bf16 v141, v41, v55
  v_dot2c_f32_bf16 v142, v41, v56
  v_dot2c_f32_bf16 v143, v41, v57
  v_dot2c_f32_bf16 v144, v42, v50
  v_dot2c_f32_bf16 v145, v42, v51
  v_dot2c_f32_bf16 v146, v42, v52
  v_dot2c_f32_bf16 v147, v42, v53
  v_dot2c_f32_bf16 v148, v42, v54
  v_dot2c_f32_bf16 v149, v42, v55
  v_dot2c_f32_bf16 v150, v42, v56
  v_dot2c_f32_bf16 v151, v42, v57
  v_dot2c_f32_bf16 v152, v43, v50
  v_dot2c_f32_bf16 v153, v43, v51
  v_dot2c_f32_bf16 v154, v43, v52
  v_dot2c_f32_bf16 v155, v43, v53
  v_dot2c_f32_bf16 v156, v43, v54
  v_dot2c_f32_bf16 v157, v43, v55
  v_dot2c_f32_bf16 v158, v43, v56
  v_dot2c_f32_bf16 v159, v43, v57
  s_waitcnt vmcnt(10)
  v_mov_b32_dpp v40, v4 row_newbcast:2 row_mask:0xf bank_mask:0xf
  v_mov_b32_dpp v41, v4 row_newbcast:10 row_mask:0xf bank_mask:0xf
  v_mov_b32_dpp v42, v7 row_newbcast:2 row_mask:0xf bank_mask:0xf
  v_mov_b32_dpp v43, v7 row_newbcast:10 row_mask:0xf bank_mask:0xf
  v_perm_b32 v50, v84, v80, s59
  v_perm_b32 v51, v84, v80, s60
  v_perm_b32 v52, v85, v81, s59
  v_perm_b32 v53, v85, v81, s60
  v_perm_b32 v54, v86, v82, s59
  v_perm_b32 v55, v86, v82, s60
  v_perm_b32 v56, v87, v83, s59
  v_perm_b32 v57, v87, v83, s60
  v_dot2c_f32_bf16 v128, v40, v50
  v_dot2c_f32_bf16 v129, v40, v51
  v_dot2c_f32_bf16 v130, v40, v52
  v_dot2c_f32_bf16 v131, v40, v53
  v_dot2c_f32_bf16 v132, v40, v54
  v_dot2c_f32_bf16 v133, v40, v55
  v_dot2c_f32_bf16 v134, v40, v56
  v_dot2c_f32_bf16 v135, v40, v57
  v_dot2c_f32_bf16 v136, v41, v50
  v_dot2c_f32_bf16 v137, v41, v51
  v_dot2c_f32_bf16 v138, v41, v52
  v_dot2c_f32_bf16 v139, v41, v53
  v_dot2c_f32_bf16 v140, v41, v54
  v_dot2c_f32_bf16 v141, v41, v55
  v_dot2c_f32_bf16 v142, v41, v56
  v_dot2c_f32_bf16 v143, v41, v57
  v_dot2c_f32_bf16 v144, v42, v50
  v_dot2c_f32_bf16 v145, v42, v51
  v_dot2c_f32_bf16 v146, v42, v52
  v_dot2c_f32_bf16 v147, v42, v53
  v_dot2c_f32_bf16 v148, v42, v54
  v_dot2c_f32_bf16 v149, v42, v55
  v_dot2c_f32_bf16 v150, v42, v56
  v_dot2c_f32_bf16 v151, v42, v57
  v_dot2c_f32_bf16 v152, v43, v50
  v_dot2c_f32_bf16 v153, v43, v51
  v_dot2c_f32_bf16 v154, v43, v52
  v_dot2c_f32_bf16 v155, v43, v53
  v_dot2c_f32_bf16 v156, v43, v54
  v_dot2c_f32_bf16 v157, v43, v55
  v_dot2c_f32_bf16 v158, v43, v56
  v_dot2c_f32_bf16 v159, v43, v57
  s_waitcnt vmcnt(8)
  v_mov_b32_dpp v40, v4 row_newbcast:3 row_mask:0xf bank_mask:0xf
  v_mov_b32_dpp v41, v4 row_newbcast:11 row_mask:0xf bank_mask:0xf
  v_mov_b32_dpp v42, v7 row_newbcast:3 row_mask:0xf bank_mask:0xf
  v_mov_b32_dpp v43, v7 row_newbcast:11 row_mask:0xf bank_mask:0xf
  v_perm_b32 v50, v92, v88, s59
  v_perm_b32 v51, v92, v88, s60
  v_perm_b32 v52, v93, v89, s59
  v_perm_b32 v53, v93, v89, s60
  v_perm_b32 v54, v94, v90, s59
  v_perm_b32 v55, v94, v90, s60
  v_perm_b32 v56, v95, v91, s59
  v_perm_b32 v57, v95, v91, s60
  v_dot2c_f32_bf16 v128, v40, v50
  v_dot2c_f32_bf16 v129, v40, v51
  v_dot2c_f32_bf16 v130, v40, v52
  v_dot2c_f32_bf16 v131, v40, v53
  v_dot2c_f32_bf16 v132, v40, v54
  v_dot2c_f32_bf16 v133, v40, v55
  v_dot2c_f32_bf16 v134, v40, v56
  v_dot2c_f32_bf16 v135, v40, v57
  v_dot2c_f32_bf16 v136, v41, v50
  v_dot2c_f32_bf16 v137, v41, v51
  v_dot2c_f32_bf16 v138, v41, v52
  v_dot2c_f32_bf16 v139, v41, v53
  v_dot2c_f32_bf16 v140, v41, v54
  v_dot2c_f32_bf16 v141, v41, v55
  v_dot2c_f32_bf16 v142, v41, v56
  v_dot2c_f32_bf16 v143, v41, v57
  v_dot2c_f32_bf16 v144, v42, v50
  v_dot2c_f32_bf16 v145, v42, v51
  v_dot2c_f32_bf16 v146, v42, v52
  v_dot2c_f32_bf16 v147, v42, v53
  v_dot2c_f32_bf16 v148, v42, v54
  v_dot2c_f32_bf16 v149, v42, v55
  v_dot2c_f32_bf16 v150, v42, v56
  v_dot2c_f32_bf16 v151, v42, v57
  v_dot2c_f32_bf16 v152, v43, v50
  v_dot2c_f32_bf16 v153, v43, v51
  v_dot2c_f32_bf16 v154, v43, v52
  v_dot2c_f32_bf16 v155, v43, v53
  v_dot2c_f32_bf16 v156, v43, v54
  v_dot2c_f32_bf16 v157, v43, v55
  v_dot2c_f32_bf16 v158, v43, v56
  v_dot2c_f32_bf16 v159, v43, v57
  s_waitcnt vmcnt(6)
  v_mov_b32_dpp v40, v4 row_newbcast:4 row_mask:0xf bank_mask:0xf
  v_mov_b32_dpp v41, v4 row_newbcast:12 row_mask:0xf bank_mask:0xf
  v_mov_b32_dpp v42, v7 row_newbcast:4 row_mask:0xf bank_mask:0xf
  v_mov_b32_dpp v43, v7 row_newbcast:12 row_mask:0xf bank_mask:0xf
  v_perm_b32 v50, v100, v96, s59
  v_perm_b32 v51, v100, v96, s60
  v_perm_b32 v52, v101, v97, s59
  v_perm_b32 v53, v101, v97, s60
  v_perm_b32 v54, v102, v98, s59
  v_perm_b32 v55, v102, v98, s60
  v_perm_b32 v56, v103, v99, s59
  v_perm_b32 v57, v103, v99, s60
  v_dot2c_f32_bf16 v128, v40, v50
  v_dot2c_f32_bf16 v129, v40, v51
  v_dot2c_f32_bf16 v130, v40, v52
  v_dot2c_f32_bf16 v131, v40, v53
  v_dot2c_f32_bf16 v132, v40, v54
  v_dot2c_f32_bf16 v133, v40, v55
  v_dot2c_f32_bf16 v134, v40, v56
  v_dot2c_f32_bf16 v135, v40, v57
  v_dot2c_f32_bf16 v136, v41, v50
  v_dot2c_f32_bf16 v137, v41, v51
  v_dot2c_f32_bf16 v138, v41, v52
  v_dot2c_f32_bf16 v139, v41, v53
  v_dot2c_f32_bf16 v140, v41, v54
  v_dot2c_f32_bf16 v141, v41, v55
  v_dot2c_f32_bf16 v142, v41, v56
  v_dot2c_f32_bf16 v143, v41, v57
  v_dot2c_f32_bf16 v144, v42, v50
  v_dot2c_f32_bf16 v145, v42, v51
  v_dot2c_f32_bf16 v146, v42, v52
  v_dot2c_f32_bf16 v147, v42, v53
  v_dot2c_f32_bf16 v148, v42, v54
  v_dot2c_f32_bf16 v149, v42, v55
  v_dot2c_f32_bf16 v150, v42, v56
  v_dot2c_f32_bf16 v151, v42, v57
  v_dot2c_f32_bf16 v152, v43, v50
  v_dot2c_f32_bf16 v153, v43, v51
  v_dot2c_f32_bf16 v154, v43, v52
  v_dot2c_f32_bf16 v155, v43, v53
  v_dot2c_f32_bf16 v156, v43, v54
  v_dot2c_f32_bf16 v157, v43, v55
  v_dot2c_f32_bf16 v158, v43, v56
  v_dot2c_f32_bf16 v159, v43, v57
  s_waitcnt vmcnt(4)
  v_mov_b32_dpp v40, v4 row_newbcast:5 row_mask:0xf bank_mask:0xf
  v_mov_b32_dpp v41, v4 row_newbcast:13 row_mask:0xf bank_mask:0xf
  v_mov_b32_dpp v42, v7 row_newbcast:5 row_mask:0xf bank_mask:0xf
  v_mov_b32_dpp v43, v7 row_newbcast:13 row_mask:0xf bank_mask:0xf
  v_perm_b32 v50, v108, v104, s59
  v_perm_b32 v51, v108, v104, s60
  v_perm_b32 v52, v109, v105, s59
  v_perm_b32 v53, v109, v105, s60
  v_perm_b32 v54, v110, v106, s59
  v_perm_b32 v55, v110, v106, s60
  v_perm_b32 v56, v111, v107, s59
  v_perm_b32 v57, v111, v107, s60
  v_dot2c_f32_bf16 v128, v40, v50
  v_dot2c_f32_bf16 v129, v40, v51
  v_dot2c_f32_bf16 v130, v40, v52
  v_dot2c_f32_bf16 v131, v40, v53
  v_dot2c_f32_bf16 v132, v40, v54
  v_dot2c_f32_bf16 v133, v40, v55
  v_dot2c_f32_bf16 v134, v40, v56
  v_dot2c_f32_bf16 v135, v40, v57
  v_dot2c_f32_bf16 v136, v41, v50
  v_dot2c_f32_bf16 v137, v41, v51
  v_dot2c_f32_bf16 v138, v41, v52
  v_dot2c_f32_bf16 v139, v41, v53
  v_dot2c_f32_bf16 v140, v41, v54
  v_dot2c_f32_bf16 v141, v41, v55
  v_dot2c_f32_bf16 v142, v41, v56
  v_dot2c_f32_bf16 v143, v41, v57
  v_dot2c_f32_bf16 v144, v42, v50
  v_dot2c_f32_bf16 v145, v42, v51
  v_dot2c_f32_bf16 v146, v42, v52
  v_dot2c_f32_bf16 v147, v42, v53
  v_dot2c_f32_bf16 v148, v42, v54
  v_dot2c_f32_bf16 v149, v42, v55
  v_dot2c_f32_bf16 v150, v42, v56
  v_dot2c_f32_bf16 v151, v42, v57
  v_dot2c_f32_bf16 v152, v43, v50
  v_dot2c_f32_bf16 v153, v43, v51
  v_dot2c_f32_bf16 v154, v43, v52
  v_dot2c_f32_bf16 v155, v43, v53
  v_dot2c_f32_bf16 v156, v43, v54
  v_dot2c_f32_bf16 v157, v43, v55
  v_dot2c_f32_bf16 v158, v43, v56
  v_dot2c_f32_bf16 v159, v43, v57
  s_waitcnt vmcnt(2)
  v_mov_b32_dpp v40, v4 row_newbcast:6 row_mask:0xf bank_mask:0xf
  v_mov_b32_dpp v41, v4 row_newbcast:14 row_mask:0xf bank_mask:0xf
  v_mov_b32_dpp v42, v7 row_newbcast:6 row_mask:0xf bank_mask:0xf
  v_mov_b32_dpp v43, v7 row_newbcast:14 row_mask:0xf bank_mask:0xf
  v_perm_b32 v50, v116, v112, s59
  v_perm_b32 v51, v116, v112, s60
  v_perm_b32 v52, v117, v113, s59
  v_perm_b32 v53, v117, v113, s60
  v_perm_b32 v54, v118, v114, s59
  v_perm_b32 v55, v118, v114, s60
  v_perm_b32 v56, v119, v115, s59
  v_perm_b32 v57, v119, v115, s60
  v_dot2c_f32_bf16 v128, v40, v50
  v_dot2c_f32_bf16 v129, v40, v51
  v_dot2c_f32_bf16 v130, v40, v52
  v_dot2c_f32_bf16 v131, v40, v53
  v_dot2c_f32_bf16 v132, v40, v54
  v_dot2c_f32_bf16 v133, v40, v55
  v_dot2c_f32_bf16 v134, v40, v56
  v_dot2c_f32_bf16 v135, v40, v57
  v_dot2c_f32_bf16 v136, v41, v50
  v_dot2c_f32_bf16 v137, v41, v51
  v_dot2c_f32_bf16 v138, v41, v52
  v_dot2c_f32_bf16 v139, v41, v53
  v_dot2c_f32_bf16 v140, v41, v54
  v_dot2c_f32_bf16 v141, v41, v55
  v_dot2c_f32_bf16 v142, v41, v56
  v_dot2c_f32_bf16 v143, v41, v57
  v_dot2c_f32_bf16 v144, v42, v50
  v_dot2c_f32_bf16 v145, v42, v51
  v_dot2c_f32_bf16 v146, v42, v52
  v_dot2c_f32_bf16 v147, v42, v53
  v_dot2c_f32_bf16 v148, v42, v54
  v_dot2c_f32_bf16 v149, v42, v55
  v_dot2c_f32_bf16 v150, v42, v56
  v_dot2c_f32_bf16 v151, v42, v57
  v_dot2c_f32_bf16 v152, v43, v50
  v_dot2c_f32_bf16 v153, v43, v51
  v_dot2c_f32_bf16 v154, v43, v52
  v_dot2c_f32_bf16 v155, v43, v53
  v_dot2c_f32_bf16 v156, v43, v54
  v_dot2c_f32_bf16 v157, v43, v55
  v_dot2c_f32_bf16 v158, v43, v56
  v_dot2c_f32_bf16 v159, v43, v57
  s_waitcnt vmcnt(0)
  v_mov_b32_dpp v40, v4 row_newbcast:7 row_mask:0xf bank_mask:0xf
  v_mov_b32_dpp v41, v4 row_newbcast:15 row_mask:0xf bank_mask:0xf
  v_mov_b32_dpp v42, v7 row_newbcast:7 row_mask:0xf bank_mask:0xf
  v_mov_b32_dpp v43, v7 row_newbcast:15 row_mask:0xf bank_mask:0xf
  v_perm_b32 v50, v124, v120, s59
  v_perm_b32 v51, v124, v120, s60
  v_perm_b32 v52, v125, v121, s59
  v_perm_b32 v53, v125, v121, s60
  v_perm_b32 v54, v126, v122, s59
  v_perm_b32 v55, v126, v122, s60
  v_perm_b32 v56, v127, v123, s59
  v_perm_b32 v57, v127, v123, s60
  v_dot2c_f32_bf16 v128, v40, v50
  v_dot2c_f32_bf16 v129, v40, v51
  v_dot2c_f32_bf16 v130, v40, v52
  v_dot2c_f32_bf16 v131, v40, v53
  v_dot2c_f32_bf16 v132, v40, v54
  v_dot2c_f32_bf16 v133, v40, v55
  v_dot2c_f32_bf16 v134, v40, v56
  v_dot2c_f32_bf16 v135, v40, v57
  v_dot2c_f32_bf16 v136, v41, v50
  v_dot2c_f32_bf16 v137, v41, v51
  v_dot2c_f32_bf16 v138, v41, v52
  v_dot2c_f32_bf16 v139, v41, v53
  v_dot2c_f32_bf16 v140, v41, v54
  v_dot2c_f32_bf16 v141, v41, v55
  v_dot2c_f32_bf16 v142, v41, v56
  v_dot2c_f32_bf16 v143, v41, v57
  v_dot2c_f32_bf16 v144, v42, v50
  v_dot2c_f32_bf16 v145, v42, v51
  v_dot2c_f32_bf16 v146, v42, v52
  v_dot2c_f32_bf16 v147, v42, v53
  v_dot2c_f32_bf16 v148, v42, v54
  v_dot2c_f32_bf16 v149, v42, v55
  v_dot2c_f32_bf16 v150, v42, v56
  v_dot2c_f32_bf16 v151, v42, v57
  v_dot2c_f32_bf16 v152, v43, v50
  v_dot2c_f32_bf16 v153, v43, v51
  v_dot2c_f32_bf16 v154, v43, v52
  v_dot2c_f32_bf16 v155, v43, v53
  v_dot2c_f32_bf16 v156, v43, v54
  v_dot2c_f32_bf16 v157, v43, v55
  v_dot2c_f32_bf16 v158, v43, v56
  v_dot2c_f32_bf16 v159, v43, v57
  v_permlane32_swap_b32 v128, v132
  v_permlane32_swap_b32 v129, v133
  v_permlane32_swap_b32 v130, v134
  v_permlane32_swap_b32 v131, v135
  v_add_f32 v128, v128, v132
  v_add_f32 v129, v129, v133
  v_add_f32 v130, v130, v134
  v_add_f32 v131, v131, v135
  s_nop 0
  v_permlane16_swap_b32 v128, v130
  v_permlane16_swap_b32 v129, v131
  v_add_f32 v128, v128, v130
  v_add_f32 v130, v129, v131
  v_mov_b32 v129, s45
  v_mov_b32 v131, s45
  buffer_store_dwordx4 v[128:131], v24, s[48:51], s65 offen sc1
  s_add_u32 s65, s65, 8192
  v_permlane32_swap_b32 v136, v140
  v_permlane32_swap_b32 v137, v141
  v_permlane32_swap_b32 v138, v142
  v_permlane32_swap_b32 v139, v143
  v_add_f32 v136, v136, v140
  v_add_f32 v137, v137, v141
  v_add_f32 v138, v138, v142
  v_add_f32 v139, v139, v143
  s_nop 0
  v_permlane16_swap_b32 v136, v138
  v_permlane16_swap_b32 v137, v139
  v_add_f32 v136, v136, v138
  v_add_f32 v138, v137, v139
  v_mov_b32 v137, s45
  v_mov_b32 v139, s45
  buffer_store_dwordx4 v[136:139], v24, s[48:51], s65 offen sc1
  s_add_u32 s65, s65, 8192
  v_permlane32_swap_b32 v144, v148
  v_permlane32_swap_b32 v145, v149
  v_permlane32_swap_b32 v146, v150
  v_permlane32_swap_b32 v147, v151
  v_add_f32 v144, v144, v148
  v_add_f32 v145, v145, v149
  v_add_f32 v146, v146, v150
  v_add_f32 v147, v147, v151
  s_nop 0
  v_permlane16_swap_b32 v144, v146
  v_permlane16_swap_b32 v145, v147
  v_add_f32 v144, v144, v146
  v_add_f32 v146, v145, v147
  v_mov_b32 v145, s45
  v_mov_b32 v147, s45
  buffer_store_dwordx4 v[144:147], v24, s[48:51], s65 offen sc1
  s_add_u32 s65, s65, 8192
  v_permlane32_swap_b32 v152, v156
  v_permlane32_swap_b32 v153, v157
  v_permlane32_swap_b32 v154, v158
  v_permlane32_swap_b32 v155, v159
  v_add_f32 v152, v152, v156
  v_add_f32 v153, v153, v157
  v_add_f32 v154, v154, v158
  v_add_f32 v155, v155, v159
  s_nop 0
  v_permlane16_swap_b32 v152, v154
  v_permlane16_swap_b32 v153, v155
  v_add_f32 v152, v152, v154
  v_add_f32 v154, v153, v155
  v_mov_b32 v153, s45
  v_mov_b32 v155, s45
  buffer_store_dwordx4 v[152:155], v24, s[48:51], s65 offen sc1
  s_mov_b32 s69, 0
  s_nop 0
L_pw_standalone__mha_block_cached__decode_kernel:
  s_sleep 2
  ds_read_b32 v28, v63 offset:34084
  s_waitcnt lgkmcnt(0)
  v_readfirstlane_b32 s3, v28
  s_add_u32 s69, s69, 1
  s_cmp_gt_u32 s69, 1048576
  s_cbranch_scc1 L_pw_done_standalone__mha_block_cached__decode_kernel
  s_cmp_eq_u32 s3, 0
  s_cbranch_scc1 L_pw_standalone__mha_block_cached__decode_kernel
L_pw_done_standalone__mha_block_cached__decode_kernel:
  s_mov_b32 s69, 0
L_pq_standalone__mha_block_cached__decode_kernel:
  buffer_load_dwordx4 v[64:67], v6, s[48:51], s66 offen offset:0 sc1
  buffer_load_dwordx4 v[68:71], v6, s[48:51], s66 offen offset:1024 sc1
  buffer_load_dwordx4 v[72:75], v6, s[48:51], s66 offen offset:2048 sc1
  buffer_load_dwordx4 v[76:79], v6, s[48:51], s66 offen offset:3072 sc1
  buffer_load_dwordx4 v[80:83], v6, s[48:51], s67 offen offset:0 sc1
  buffer_load_dwordx4 v[84:87], v6, s[48:51], s67 offen offset:1024 sc1
  buffer_load_dwordx4 v[88:91], v6, s[48:51], s67 offen offset:2048 sc1
  buffer_load_dwordx4 v[92:95], v6, s[48:51], s67 offen offset:3072 sc1
  s_waitcnt vmcnt(0)
  v_xor_b32 v34, s45, v65
  v_xor_b32 v35, s45, v67
  v_xor_b32 v36, s45, v69
  v_xor_b32 v37, s45, v71
  v_or_b32 v34, v34, v36
  v_or_b32 v35, v35, v37
  v_xor_b32 v36, s45, v73
  v_xor_b32 v37, s45, v75
  v_or_b32 v34, v34, v36
  v_or_b32 v35, v35, v37
  v_xor_b32 v36, s45, v77
  v_xor_b32 v37, s45, v79
  v_or_b32 v34, v34, v36
  v_or_b32 v35, v35, v37
  v_xor_b32 v36, s45, v81
  v_xor_b32 v37, s45, v83
  v_or_b32 v34, v34, v36
  v_or_b32 v35, v35, v37
  v_xor_b32 v36, s45, v85
  v_xor_b32 v37, s45, v87
  v_or_b32 v34, v34, v36
  v_or_b32 v35, v35, v37
  v_xor_b32 v36, s45, v89
  v_xor_b32 v37, s45, v91
  v_or_b32 v34, v34, v36
  v_or_b32 v35, v35, v37
  v_xor_b32 v36, s45, v93
  v_xor_b32 v37, s45, v95
  v_or_b32 v34, v34, v36
  v_or_b32 v35, v35, v37
  v_or_b32 v34, v34, v35
  v_cmp_ne_u32 vcc, 0, v34
  s_add_u32 s69, s69, 1
  s_cmp_gt_u32 s69, 1048576
  s_cbranch_scc1 L_pq_standalone__mha_block_cached__decode_kernel_done
  s_cbranch_vccz L_pq_standalone__mha_block_cached__decode_kernel_done
  s_mov_b64 exec, vcc
  s_sleep 4
  s_branch L_pq_standalone__mha_block_cached__decode_kernel
L_pq_standalone__mha_block_cached__decode_kernel_done:
  s_mov_b64 exec, -1
  v_add_f32 v64, v64, v80
  v_add_f32 v66, v66, v82
  v_add_f32 v68, v68, v84
  v_add_f32 v70, v70, v86
  v_add_f32 v72, v72, v88
  v_add_f32 v74, v74, v90
  v_add_f32 v76, v76, v92
  v_add_f32 v78, v78, v94
  v_add_f32 v64, v64, v72
  v_add_f32 v66, v66, v74
  v_add_f32 v68, v68, v76
  v_add_f32 v70, v70, v78
  v_add_f32 v64, v64, v68
  v_add_f32 v66, v66, v70
  v_cvt_pk_bf16_f32 v30, v64, v66
  v_lshlrev_b32 v31, 2, v59
  ds_write_b32 v31, v30 offset:33792
  v_mov_b32 v32, s45
  ds_write_b32 v63, v32 offset:34088
  s_waitcnt lgkmcnt(0)
  s_barrier
  s_lshl_b32 s68, s87, 7
  s_add_u32 s68, s68, 1048576
  s_lshl_b32 s66, s53, 5
  s_add_u32 s66, s66, s52
  s_lshl_b32 s66, s66, 13
  s_add_u32 s67, s66, 4096
  s_mov_b32 s69, 0
L_pmx_standalone__mha_block_cached__decode_kernel:
  s_sleep 8
  ds_read_b128 v[20:23], v63 offset:34048
  ds_read_b128 v[24:27], v63 offset:34064
  s_waitcnt lgkmcnt(0)
  v_max3_u32 v28, v20, v21, v22
  v_max3_u32 v28, v28, v23, v24
  v_max3_u32 v28, v28, v25, v26
  v_max_u32 v28, v28, v27
  v_cmp_eq_u32 vcc, -1, v28
  s_add_u32 s69, s69, 1
  s_cmp_gt_u32 s69, 1048576
  s_cbranch_scc1 L_pmx_done_standalone__mha_block_cached__decode_kernel
  s_cbranch_vccnz L_pmx_standalone__mha_block_cached__decode_kernel
  s_nop 0
L_pmx_done_standalone__mha_block_cached__decode_kernel:
  v_max3_f32 v44, v20, v22, v24
  v_max_f32 v44, v44, v26
  v_sub_f32 v32, v20, v44
  v_sub_f32 v33, v22, v44
  v_sub_f32 v34, v24, v44
  v_sub_f32 v35, v26, v44
  v_exp_f32 v32, v32
  v_exp_f32 v33, v33
  v_exp_f32 v34, v34
  v_exp_f32 v35, v35
  v_mul_f32 v46, v32, v21
  v_fmac_f32 v46, v33, v23
  v_fmac_f32 v46, v34, v25
  v_fmac_f32 v46, v35, v27
  v_mov_b32 v45, s45
  v_mov_b32 v47, s45
  s_xor_b32 s3, s68, 128
  s_mov_b64 exec, 1
  buffer_store_dwordx4 v[44:47], off, s[48:51], s3 sc1
  s_mov_b32 s69, 0
  s_nop 0
L_ppg_standalone__mha_block_cached__decode_kernel:
  s_sleep 16
  ds_read_b32 v28, v63 offset:34080
  s_waitcnt lgkmcnt(0)
  v_readfirstlane_b32 s3, v28
  s_add_u32 s69, s69, 1
  s_cmp_gt_u32 s69, 1048576
  s_cbranch_scc1 L_ppg_done_standalone__mha_block_cached__decode_kernel
  s_cmp_lt_u32 s3, 4
  s_cbranch_scc1 L_ppg_standalone__mha_block_cached__decode_kernel
L_ppg_done_standalone__mha_block_cached__decode_kernel:
  s_mov_b32 s69, 0
L_pml_standalone__mha_block_cached__decode_kernel:
  buffer_load_dwordx4 v[36:39], off, s[48:51], s68 sc1
  s_waitcnt vmcnt(0)
  v_xor_b32 v40, s45, v37
  v_xor_b32 v41, s45, v39
  v_or_b32 v40, v40, v41
  v_cmp_ne_u32 vcc, 0, v40
  s_add_u32 s69, s69, 1
  s_cmp_gt_u32 s69, 1048576
  s_cbranch_scc1 L_pml_done_standalone__mha_block_cached__decode_kernel
  s_cbranch_vccz L_pml_done_standalone__mha_block_cached__decode_kernel
  s_sleep 16
  s_branch L_pml_standalone__mha_block_cached__decode_kernel
L_pml_done_standalone__mha_block_cached__decode_kernel:
  v_max_f32 v40, v44, v36
  v_sub_f32 v41, v44, v40
  v_sub_f32 v42, v36, v40
  v_exp_f32 v41, v41
  v_exp_f32 v42, v42
  v_sub_f32 v32, v20, v40
  v_sub_f32 v33, v22, v40
  v_sub_f32 v34, v24, v40
  v_sub_f32 v35, v26, v40
  v_mul_f32 v41, v41, v46
  v_fmac_f32 v41, v42, v38
  v_exp_f32 v32, v32
  v_exp_f32 v33, v33
  v_exp_f32 v34, v34
  v_exp_f32 v35, v35
  v_rcp_f32 v41, v41
  s_nop 0
  v_mul_f32 v32, v32, v41
  v_mul_f32 v33, v33, v41
  v_mul_f32 v34, v34, v41
  v_mul_f32 v35, v35, v41
  ds_write_b128 v63, v[32:35] offset:34096
  s_mov_b64 exec, -1
  v_lshlrev_b32 v23, 2, v59
  s_lshl_b32 s3, s53, 10
  s_lshl_b32 s65, s52, 5
  s_add_u32 s65, s3, s65
  s_waitcnt lgkmcnt(0)
  s_barrier
  s_cmp_lg_u32 s54, 0
  s_cbranch_scc1 L_hfin_standalone__mha_block_cached__decode_kernel
  s_mov_b32 s69, 0
L_pin_standalone__mha_block_cached__decode_kernel:
  buffer_load_dwordx4 v[64:67], v6, s[48:51], s66 offen offset:0 sc1
  buffer_load_dwordx4 v[68:71], v6, s[48:51], s66 offen offset:1024 sc1
  buffer_load_dwordx4 v[72:75], v6, s[48:51], s66 offen offset:2048 sc1
  buffer_load_dwordx4 v[76:79], v6, s[48:51], s66 offen offset:3072 sc1
  buffer_load_dwordx4 v[80:83], v6, s[48:51], s67 offen offset:0 sc1
  buffer_load_dwordx4 v[84:87], v6, s[48:51], s67 offen offset:1024 sc1
  buffer_load_dwordx4 v[88:91], v6, s[48:51], s67 offen offset:2048 sc1
  buffer_load_dwordx4 v[92:95], v6, s[48:51], s67 offen offset:3072 sc1
  s_waitcnt vmcnt(0)
  v_xor_b32 v34, s45, v65
  v_xor_b32 v35, s45, v67
  v_xor_b32 v36, s45, v69
  v_xor_b32 v37, s45, v71
  v_or_b32 v34, v34, v36
  v_or_b32 v35, v35, v37
  v_xor_b32 v36, s45, v73
  v_xor_b32 v37, s45, v75
  v_or_b32 v34, v34, v36
  v_or_b32 v35, v35, v37
  v_xor_b32 v36, s45, v77
  v_xor_b32 v37, s45, v79
  v_or_b32 v34, v34, v36
  v_or_b32 v35, v35, v37
  v_xor_b32 v36, s45, v81
  v_xor_b32 v37, s45, v83
  v_or_b32 v34, v34, v36
  v_or_b32 v35, v35, v37
  v_xor_b32 v36, s45, v85
  v_xor_b32 v37, s45, v87
  v_or_b32 v34, v34, v36
  v_or_b32 v35, v35, v37
  v_xor_b32 v36, s45, v89
  v_xor_b32 v37, s45, v91
  v_or_b32 v34, v34, v36
  v_or_b32 v35, v35, v37
  v_xor_b32 v36, s45, v93
  v_xor_b32 v37, s45, v95
  v_or_b32 v34, v34, v36
  v_or_b32 v35, v35, v37
  v_or_b32 v34, v34, v35
  v_cmp_ne_u32 vcc, 0, v34
  s_add_u32 s69, s69, 1
  s_cmp_gt_u32 s69, 1048576
  s_cbranch_scc1 L_pin_standalone__mha_block_cached__decode_kernel_done
  s_cbranch_vccz L_pin_standalone__mha_block_cached__decode_kernel_done
  s_mov_b64 exec, vcc
  s_branch L_pin_standalone__mha_block_cached__decode_kernel
L_pin_standalone__mha_block_cached__decode_kernel_done:
  s_mov_b64 exec, -1
  v_add_f32 v64, v64, v80
  v_add_f32 v66, v66, v82
  v_add_f32 v68, v68, v84
  v_add_f32 v70, v70, v86
  v_add_f32 v72, v72, v88
  v_add_f32 v74, v74, v90
  v_add_f32 v76, v76, v92
  v_add_f32 v78, v78, v94
  v_add_f32 v64, v64, v72
  v_add_f32 v66, v66, v74
  v_add_f32 v68, v68, v76
  v_add_f32 v70, v70, v78
  v_add_f32 v64, v64, v68
  v_add_f32 v66, v66, v70
  s_nop 0
  v_add_f32_dpp v64, v64, v64 row_ror:8 row_mask:0xf bank_mask:0xf
  v_add_f32_dpp v66, v66, v66 row_ror:8 row_mask:0xf bank_mask:0xf
  s_nop 1
  v_permlane32_swap_b32 v64, v66
  v_add_f32 v64, v64, v66
  v_mov_b32 v66, v64
  s_nop 1
  v_permlane16_swap_b32 v64, v66
  v_add_f32 v64, v64, v66
  v_mov_b32 v66, v64
  s_nop 1
  v_permlane32_swap_b32 v64, v66
  v_cvt_pk_bf16_f32 v22, v64, v66
  s_mov_b64 exec, 0xff
  buffer_store_dword v22, v23, s[36:39], s65 offen
  s_cmp_lg_u32 s87, 0
  s_cbranch_scc1 L_noep_standalone__mha_block_cached__decode_kernel
  s_mov_b64 exec, 1
  v_mov_b32 v24, s45
  s_mov_b32 s3, 3145728
  buffer_store_dword v24, off, s[48:51], s3
L_noep_standalone__mha_block_cached__decode_kernel:
  s_mov_b64 exec, -1
L_hfin_standalone__mha_block_cached__decode_kernel:
L_end_standalone__mha_block_cached__decode_kernel:
  s_endpgm
.section .rodata,"a"
.p2align 6
.amdhsa_kernel standalone__mha_block_cached__decode_kernel
  .amdhsa_next_free_vgpr 256
  .amdhsa_next_free_sgpr 96
  .amdhsa_accum_offset 256
  .amdhsa_group_segment_fixed_size 0
  .amdhsa_kernarg_size 64
  .amdhsa_user_sgpr_count 2
  .amdhsa_user_sgpr_kernarg_segment_ptr 1
  .amdhsa_system_sgpr_workgroup_id_x 1
.end_amdhsa_kernel
```
